```python
import torch

def _softmax(x, axis=-1):
    return torch.softmax(x, dim=axis)
def _gelu(x):
    return torch.nn.functional.gelu(x, approximate="tanh")
def _silu(x):
    return torch.nn.functional.silu(x)
def _sigmoid(x):
    return torch.sigmoid(x)
def _layernorm(x, axis=-1, eps=1e-5):
    m = x.mean(dim=axis, keepdim=True)
    v = x.var(dim=axis, keepdim=True, unbiased=False)
    return (x - m) / torch.sqrt(v + eps)
def _scatter_add(tgt, idx, src, axis=0):
    return tgt.clone().index_add_(axis, idx, src)
def _segment_sum(src, seg, n):
    out = torch.zeros((n,) + src.shape[1:], dtype=src.dtype)
    return out.index_add_(0, seg, src)
def _pad(x, pw):
    flat = tuple(v for pair in reversed(pw) for v in pair)
    return torch.nn.functional.pad(x, flat)

kernel_name = 'standalone__gqa_softmax__near_ridge'

def setup_inputs():

    _w = (lambda a: (lambda t: t.to(torch.bfloat16) if t.is_floating_point() else t)(torch.as_tensor(a)))
    B, Hq, Hkv, Sq, Sk, D = 16, 32, 32, 384, 1024, 128
    return {
        "q": _w((lambda *s: torch.randn(*s, dtype=torch.bfloat16) * 0.8)(B, Hq, Sq, D)),
        "k": _w((lambda *s: torch.randn(*s, dtype=torch.bfloat16) * 0.8)(B, Hkv, Sk, D)),
        "v": _w((lambda *s: torch.randn(*s, dtype=torch.bfloat16) * 0.05)(B, Hkv, Sk, D)),
    }

def reference(q, k, v):
    B, Hq, Sq, D = q.shape
    Hkv = k.shape[1]
    rep = Hq // Hkv
    k = (lambda x, n, axis: torch.repeat_interleave(x, n, dim=axis))(k, rep, axis=1)
    v = (lambda x, n, axis: torch.repeat_interleave(x, n, dim=axis))(v, rep, axis=1)
    scale = D ** -0.5
    scores = torch.einsum("bhqd,bhkd->bhqk", q, k) * scale
    p = _softmax(scores, axis=-1)
    return torch.einsum("bhqk,bhkd->bhqd", p, v)
```

```asm
; @launch grid=(256,1,1) block=(256,1,1) lds=163840
.amdgcn_target "amdgcn-amd-amdhsa--gfx950"
.text
.globl standalone__gqa_softmax__near_ridge_kernel
.p2align 8
.type standalone__gqa_softmax__near_ridge_kernel,@function
standalone__gqa_softmax__near_ridge_kernel:
s_cmp_ge_u32 s2, 0x100
s_cbranch_scc1 L_end
s_load_dwordx4 s[52:55], s[0:1], 0
s_getpc_b64 s[64:65]
v_lshlrev_b32 v12, 6, v0
v_mov_b32 v13, s65
v_add_co_u32 v12, vcc, s64, v12
s_nop 1
v_addc_co_u32 v13, vcc, 0, v13, vcc
global_load_dword v255, v[12:13], off
s_load_dwordx4 s[56:59], s[0:1], 16
v_lshrrev_b32 v1, 6, v0
v_and_b32 v0, 63, v0
v_readfirstlane_b32 s25, v1
v_and_b32 v2, 15, v0
v_lshrrev_b32 v3, 4, v0
s_and_b32 s30, s25, 1
s_lshr_b32 s31, s25, 1
s_lshl_b32 s31, s31, 2
s_add_u32 s31, s31, s30
s_lshl_b32 s22, s31, 10
s_lshl_b32 s30, s30, 2
v_add_u32 v6, s30, v3
v_lshlrev_b32 v6, 1, v6
v_xor_b32 v6, v6, v2
v_lshlrev_b32 v6, 4, v6
v_lshl_add_u32 v6, v3, 8, v6
v_add_u32 v244, s22, v6
s_mov_b32 s24, 0x3e0293ee
s_mov_b32 s43, 0
s_mov_b32 s42, 0x40000000
s_mov_b32 s44, 0
s_mov_b32 s39, 0
s_mov_b64 s[50:51], 0
s_mov_b32 s6, 0x80000
s_mov_b32 s7, 0x20000
s_mov_b32 s10, 0x80000
s_mov_b32 s11, 0x20000
s_mov_b32 s14, 0x30000
s_mov_b32 s15, 0x20000
s_mov_b32 s18, 0x30000
s_mov_b32 s19, 0x20000
s_mov_b32 s62, s2
s_lshl_b32 s30, s62, 19
s_mul_i32 s31, s62, 0x30000
s_waitcnt lgkmcnt(0)
s_add_u32 s4, s54, s30
s_addc_u32 s5, s55, 0
s_add_u32 s12, s52, s31
s_addc_u32 s13, s53, 0
s_add_u32 s8, s56, s30
s_addc_u32 s9, s57, 0
s_add_u32 s16, s58, s31
s_addc_u32 s17, s59, 0
L_cold:
s_lshl_b32 s20, s39, 18
s_mov_b32 s21, s20
s_mul_i32 s38, s39, 0x18000
s_mul_i32 s26, s25, 0x6000
s_add_u32 s26, s26, s38
s_mov_b32 s35, 0
s_add_u32 m0, s22, 0x0
s_nop 0
buffer_load_dwordx4 v244, s[4:7], s20 offen nt lds
buffer_load_dwordx4 v244, s[4:7], s20 offen offset:2048 nt lds
s_add_u32 s20, s20, 0x2000
s_add_u32 s30, s38, 0x0
s_add_u32 m0, s22, 0x10000
s_nop 0
buffer_load_dwordx4 v244, s[12:15], s30 offen nt lds
buffer_load_dwordx4 v244, s[12:15], s30 offen offset:2048 nt lds
s_add_u32 s30, s38, 0x6000
s_add_u32 m0, s22, 0x16000
s_nop 0
buffer_load_dwordx4 v244, s[12:15], s30 offen nt lds
buffer_load_dwordx4 v244, s[12:15], s30 offen offset:2048 nt lds
s_add_u32 s30, s38, 0xc000
s_add_u32 m0, s22, 0x1c000
s_nop 0
buffer_load_dwordx4 v244, s[12:15], s30 offen nt lds
buffer_load_dwordx4 v244, s[12:15], s30 offen offset:2048 nt lds
s_add_u32 s30, s38, 0x12000
s_add_u32 m0, s22, 0x22000
s_nop 0
buffer_load_dwordx4 v244, s[12:15], s30 offen nt lds
buffer_load_dwordx4 v244, s[12:15], s30 offen offset:2048 nt lds
s_add_u32 m0, s22, 0x2000
s_nop 0
buffer_load_dwordx4 v244, s[4:7], s20 offen nt lds
buffer_load_dwordx4 v244, s[4:7], s20 offen offset:2048 nt lds
s_add_u32 s20, s20, 0x2000
s_add_u32 s30, s38, 0x2000
s_add_u32 m0, s22, 0x12000
s_nop 0
buffer_load_dwordx4 v244, s[12:15], s30 offen nt lds
buffer_load_dwordx4 v244, s[12:15], s30 offen offset:2048 nt lds
s_add_u32 s30, s38, 0x8000
s_add_u32 m0, s22, 0x18000
s_nop 0
buffer_load_dwordx4 v244, s[12:15], s30 offen nt lds
buffer_load_dwordx4 v244, s[12:15], s30 offen offset:2048 nt lds
s_add_u32 s30, s38, 0xe000
s_add_u32 m0, s22, 0x1e000
s_nop 0
buffer_load_dwordx4 v244, s[12:15], s30 offen nt lds
buffer_load_dwordx4 v244, s[12:15], s30 offen offset:2048 nt lds
s_add_u32 s30, s38, 0x14000
s_add_u32 m0, s22, 0x24000
s_nop 0
buffer_load_dwordx4 v244, s[12:15], s30 offen nt lds
buffer_load_dwordx4 v244, s[12:15], s30 offen offset:2048 nt lds
s_cmp_lg_u32 s44, 0
s_cbranch_scc1 L_nos2
v_mbcnt_lo_u32_b32 v0, -1, 0
v_mbcnt_hi_u32_b32 v0, -1, v0
v_and_b32 v2, 15, v0
v_lshrrev_b32 v3, 4, v0
v_and_b32 v5, 7, v2
v_lshlrev_b32 v5, 1, v5
v_xor_b32 v5, v5, v3
v_lshlrev_b32 v5, 4, v5
v_lshl_add_u32 v5, v2, 8, v5
v_xor_b32 v232, 0x0, v5
v_xor_b32 v233, 0x40, v5
v_xor_b32 v234, 0x80, v5
v_xor_b32 v235, 0xc0, v5
v_bfe_u32 v6, v0, 2, 2
v_and_b32 v7, 3, v0
v_lshl_add_u32 v8, v3, 2, v6
v_and_b32 v9, 7, v8
v_lshlrev_b32 v8, 8, v8
v_lshl_add_u32 v8, v9, 5, v8
v_lshl_add_u32 v8, v7, 3, v8
v_add_u32 v8, 0x8000, v8
v_xor_b32 v236, 0x0, v8
v_xor_b32 v237, 0x20, v8
v_xor_b32 v238, 0x40, v8
v_xor_b32 v239, 0x60, v8
v_xor_b32 v240, 0x80, v8
v_xor_b32 v241, 0xa0, v8
v_xor_b32 v242, 0xc0, v8
v_xor_b32 v243, 0xe0, v8
v_lshlrev_b32 v245, 4, v0
s_mul_i32 s40, s25, 0x6000
s_add_u32 s40, s40, 0x10000
L_nos2:
s_getpc_b64 s[64:65]
L_pfa:
s_add_u32 s64, s64, L_it0-L_pfa
s_addc_u32 s65, s65, 0
s_lshl_b32 s66, s25, 12
s_add_u32 s64, s64, s66
s_addc_u32 s65, s65, 0
v_mbcnt_lo_u32_b32 v12, -1, 0
v_mbcnt_hi_u32_b32 v12, -1, v12
v_lshlrev_b32 v12, 6, v12
v_mov_b32 v13, s65
v_add_co_u32 v12, vcc, s64, v12
s_nop 1
v_addc_co_u32 v13, vcc, 0, v13, vcc
global_load_dword v255, v[12:13], off
v_add_co_u32 v12, vcc, 0x4000, v12
s_nop 1
v_addc_co_u32 v13, vcc, 0, v13, vcc
global_load_dword v255, v[12:13], off
v_add_u32 v12, s40, v232
v_add_u32 v13, s40, v233
v_add_u32 v14, s40, v234
v_add_u32 v15, s40, v235
s_waitcnt vmcnt(12)
s_barrier
ds_read_b128 v[112:115], v12 offset:0
ds_read_b128 v[116:119], v13 offset:0
ds_read_b128 v[120:123], v14 offset:0
ds_read_b128 v[124:127], v15 offset:0
ds_read_b128 v[128:131], v12 offset:4096
ds_read_b128 v[132:135], v13 offset:4096
ds_read_b128 v[136:139], v14 offset:4096
ds_read_b128 v[140:143], v15 offset:4096
ds_read_b128 a[192:195], v232 offset:0
ds_read_b128 a[196:199], v233 offset:0
ds_read_b128 a[200:203], v234 offset:0
ds_read_b128 a[204:207], v235 offset:0
ds_read_b128 a[208:211], v232 offset:4096
ds_read_b128 a[212:215], v233 offset:4096
ds_read_b128 a[216:219], v234 offset:4096
s_waitcnt lgkmcnt(13)
ds_read_b128 a[220:223], v235 offset:4096
s_add_u32 s30, s38, 0x4000
s_add_u32 m0, s22, 0x14000
v_lshlrev_b32 v4, 16, v112
v_and_b32 v5, 0xffff0000, v112
buffer_load_dwordx4 v244, s[12:15], s30 offen nt lds
v_mul_f32 v4, s24, v4
v_mul_f32 v5, s24, v5
v_cvt_pk_bf16_f32 v112, v4, v5
v_lshlrev_b32 v6, 16, v113
v_and_b32 v7, 0xffff0000, v113
v_mul_f32 v6, s24, v6
v_mul_f32 v7, s24, v7
v_cvt_pk_bf16_f32 v113, v6, v7
v_lshlrev_b32 v8, 16, v114
v_and_b32 v9, 0xffff0000, v114
v_mul_f32 v8, s24, v8
v_mul_f32 v9, s24, v9
v_cvt_pk_bf16_f32 v114, v8, v9
v_lshlrev_b32 v10, 16, v115
v_and_b32 v11, 0xffff0000, v115
v_mul_f32 v10, s24, v10
v_mul_f32 v11, s24, v11
v_cvt_pk_bf16_f32 v115, v10, v11
v_lshlrev_b32 v4, 16, v116
v_and_b32 v5, 0xffff0000, v116
buffer_load_dwordx4 v244, s[12:15], s30 offen offset:2048 nt lds
v_mul_f32 v4, s24, v4
v_mul_f32 v5, s24, v5
v_cvt_pk_bf16_f32 v116, v4, v5
v_lshlrev_b32 v6, 16, v117
v_and_b32 v7, 0xffff0000, v117
v_mul_f32 v6, s24, v6
v_mul_f32 v7, s24, v7
v_cvt_pk_bf16_f32 v117, v6, v7
v_lshlrev_b32 v8, 16, v118
v_and_b32 v9, 0xffff0000, v118
v_mul_f32 v8, s24, v8
v_mul_f32 v9, s24, v9
v_cvt_pk_bf16_f32 v118, v8, v9
v_lshlrev_b32 v10, 16, v119
v_and_b32 v11, 0xffff0000, v119
v_mul_f32 v10, s24, v10
v_mul_f32 v11, s24, v11
v_cvt_pk_bf16_f32 v119, v10, v11
s_add_u32 s30, s38, 0xa000
s_add_u32 m0, s22, 0x1a000
s_waitcnt lgkmcnt(13)
v_lshlrev_b32 v4, 16, v120
v_and_b32 v5, 0xffff0000, v120
buffer_load_dwordx4 v244, s[12:15], s30 offen nt lds
v_mul_f32 v4, s24, v4
v_mul_f32 v5, s24, v5
v_cvt_pk_bf16_f32 v120, v4, v5
v_lshlrev_b32 v6, 16, v121
v_and_b32 v7, 0xffff0000, v121
v_mul_f32 v6, s24, v6
v_mul_f32 v7, s24, v7
v_cvt_pk_bf16_f32 v121, v6, v7
v_lshlrev_b32 v8, 16, v122
v_and_b32 v9, 0xffff0000, v122
v_mul_f32 v8, s24, v8
v_mul_f32 v9, s24, v9
v_cvt_pk_bf16_f32 v122, v8, v9
v_lshlrev_b32 v10, 16, v123
v_and_b32 v11, 0xffff0000, v123
v_mul_f32 v10, s24, v10
v_mul_f32 v11, s24, v11
v_cvt_pk_bf16_f32 v123, v10, v11
s_waitcnt lgkmcnt(12)
v_lshlrev_b32 v4, 16, v124
v_and_b32 v5, 0xffff0000, v124
buffer_load_dwordx4 v244, s[12:15], s30 offen offset:2048 nt lds
v_mul_f32 v4, s24, v4
v_mul_f32 v5, s24, v5
v_cvt_pk_bf16_f32 v124, v4, v5
v_lshlrev_b32 v6, 16, v125
v_and_b32 v7, 0xffff0000, v125
v_mul_f32 v6, s24, v6
v_mul_f32 v7, s24, v7
v_cvt_pk_bf16_f32 v125, v6, v7
v_lshlrev_b32 v8, 16, v126
v_and_b32 v9, 0xffff0000, v126
v_mul_f32 v8, s24, v8
v_mul_f32 v9, s24, v9
v_cvt_pk_bf16_f32 v126, v8, v9
v_lshlrev_b32 v10, 16, v127
v_and_b32 v11, 0xffff0000, v127
v_mul_f32 v10, s24, v10
v_mul_f32 v11, s24, v11
v_cvt_pk_bf16_f32 v127, v10, v11
s_add_u32 s30, s38, 0x10000
s_add_u32 m0, s22, 0x20000
s_waitcnt lgkmcnt(11)
v_lshlrev_b32 v4, 16, v128
v_and_b32 v5, 0xffff0000, v128
buffer_load_dwordx4 v244, s[12:15], s30 offen nt lds
v_mul_f32 v4, s24, v4
v_mul_f32 v5, s24, v5
v_cvt_pk_bf16_f32 v128, v4, v5
s_waitcnt lgkmcnt(7)
v_mfma_f32_16x16x32_bf16 v[16:19], a[192:195], v[112:115], 0
v_lshlrev_b32 v6, 16, v129
v_and_b32 v7, 0xffff0000, v129
v_mul_f32 v6, s24, v6
s_waitcnt lgkmcnt(6)
v_mfma_f32_16x16x32_bf16 v[16:19], a[196:199], v[116:119], v[16:19]
v_mul_f32 v7, s24, v7
v_cvt_pk_bf16_f32 v129, v6, v7
v_lshlrev_b32 v8, 16, v130
s_waitcnt lgkmcnt(5)
v_mfma_f32_16x16x32_bf16 v[16:19], a[200:203], v[120:123], v[16:19]
v_and_b32 v9, 0xffff0000, v130
v_mul_f32 v8, s24, v8
v_mul_f32 v9, s24, v9
s_waitcnt lgkmcnt(4)
v_mfma_f32_16x16x32_bf16 v[16:19], a[204:207], v[124:127], v[16:19]
v_cvt_pk_bf16_f32 v130, v8, v9
v_lshlrev_b32 v10, 16, v131
v_and_b32 v11, 0xffff0000, v131
s_waitcnt lgkmcnt(3)
v_mfma_f32_16x16x32_bf16 v[20:23], a[208:211], v[112:115], 0
v_mul_f32 v10, s24, v10
v_mul_f32 v11, s24, v11
buffer_load_dwordx4 v244, s[12:15], s30 offen offset:2048 nt lds
v_cvt_pk_bf16_f32 v131, v10, v11
s_waitcnt lgkmcnt(2)
v_mfma_f32_16x16x32_bf16 v[20:23], a[212:215], v[116:119], v[20:23]
v_lshlrev_b32 v4, 16, v132
v_and_b32 v5, 0xffff0000, v132
v_mul_f32 v4, s24, v4
s_waitcnt lgkmcnt(1)
v_mfma_f32_16x16x32_bf16 v[20:23], a[216:219], v[120:123], v[20:23]
v_mul_f32 v5, s24, v5
v_cvt_pk_bf16_f32 v132, v4, v5
v_lshlrev_b32 v6, 16, v133
s_waitcnt lgkmcnt(0)
v_mfma_f32_16x16x32_bf16 v[20:23], a[220:223], v[124:127], v[20:23]
v_and_b32 v7, 0xffff0000, v133
v_mul_f32 v6, s24, v6
v_mul_f32 v7, s24, v7
v_cvt_pk_bf16_f32 v133, v6, v7
v_lshlrev_b32 v8, 16, v134
v_and_b32 v9, 0xffff0000, v134
v_mul_f32 v8, s24, v8
v_mul_f32 v9, s24, v9
v_cvt_pk_bf16_f32 v134, v8, v9
v_lshlrev_b32 v10, 16, v135
s_add_u32 s30, s38, 0x16000
s_add_u32 m0, s22, 0x26000
v_and_b32 v11, 0xffff0000, v135
v_mul_f32 v10, s24, v10
buffer_load_dwordx4 v244, s[12:15], s30 offen nt lds
v_mul_f32 v11, s24, v11
v_cvt_pk_bf16_f32 v135, v10, v11
v_lshlrev_b32 v4, 16, v136
v_and_b32 v5, 0xffff0000, v136
v_mul_f32 v4, s24, v4
v_mul_f32 v5, s24, v5
v_cvt_pk_bf16_f32 v136, v4, v5
v_lshlrev_b32 v6, 16, v137
v_and_b32 v7, 0xffff0000, v137
v_mul_f32 v6, s24, v6
v_mul_f32 v7, s24, v7
v_cvt_pk_bf16_f32 v137, v6, v7
v_lshlrev_b32 v8, 16, v138
v_and_b32 v9, 0xffff0000, v138
v_mul_f32 v8, s24, v8
v_mul_f32 v9, s24, v9
v_cvt_pk_bf16_f32 v138, v8, v9
v_lshlrev_b32 v10, 16, v139
v_and_b32 v11, 0xffff0000, v139
v_mul_f32 v10, s24, v10
v_mul_f32 v11, s24, v11
v_cvt_pk_bf16_f32 v139, v10, v11
buffer_load_dwordx4 v244, s[12:15], s30 offen offset:2048 nt lds
v_lshlrev_b32 v4, 16, v140
v_and_b32 v5, 0xffff0000, v140
v_mul_f32 v4, s24, v4
v_mul_f32 v5, s24, v5
v_cvt_pk_bf16_f32 v140, v4, v5
v_lshlrev_b32 v6, 16, v141
v_and_b32 v7, 0xffff0000, v141
v_mul_f32 v6, s24, v6
v_mul_f32 v7, s24, v7
v_cvt_pk_bf16_f32 v141, v6, v7
v_lshlrev_b32 v8, 16, v142
v_and_b32 v9, 0xffff0000, v142
v_mul_f32 v8, s24, v8
v_mul_f32 v9, s24, v9
v_cvt_pk_bf16_f32 v142, v8, v9
v_lshlrev_b32 v10, 16, v143
v_and_b32 v11, 0xffff0000, v143
v_mul_f32 v10, s24, v10
v_mul_f32 v11, s24, v11
v_cvt_pk_bf16_f32 v143, v10, v11
v_max3_f32 v0, v16, v17, v18
v_max3_f32 v0, v0, v19, v20
v_mfma_f32_16x16x32_bf16 v[24:27], a[192:195], v[128:131], 0
v_max3_f32 v0, v0, v21, v22
v_max_f32 v0, v0, v23
v_mfma_f32_16x16x32_bf16 v[24:27], a[196:199], v[132:135], v[24:27]
v_mov_b32 v1, v0
s_nop 0
s_nop 0
v_permlane16_swap_b32 v0, v1
v_mfma_f32_16x16x32_bf16 v[24:27], a[200:203], v[136:139], v[24:27]
v_max_f32 v0, v0, v1
v_mov_b32 v1, v0
v_mfma_f32_16x16x32_bf16 v[24:27], a[204:207], v[140:143], v[24:27]
s_nop 0
v_permlane32_swap_b32 v0, v1
v_max_f32 v0, v0, v1
v_mfma_f32_16x16x32_bf16 v[28:31], a[208:211], v[128:131], 0
v_sub_f32 v0, 0, v0
v_cndmask_b32 v0, v0, v208, s[50:51]
v_mfma_f32_16x16x32_bf16 v[28:31], a[212:215], v[132:135], v[28:31]
v_mov_b32 v208, v0
v_mov_b32 v209, v0
v_mfma_f32_16x16x32_bf16 v[28:31], a[216:219], v[136:139], v[28:31]
v_mov_b32 v210, v0
v_mov_b32 v211, v0
v_mfma_f32_16x16x32_bf16 v[28:31], a[220:223], v[140:143], v[28:31]
v_add_f32 v16, v16, v0
v_add_f32 v17, v17, v0
v_add_f32 v18, v18, v0
v_add_f32 v19, v19, v0
v_add_f32 v20, v20, v0
v_add_f32 v21, v21, v0
v_add_f32 v22, v22, v0
v_add_f32 v23, v23, v0
v_mov_b32 v246, 0
v_exp_f32 v16, v16
v_exp_f32 v17, v17
v_exp_f32 v18, v18
v_add_f32 v246, v246, v16
v_exp_f32 v19, v19
v_add_f32 v246, v246, v17
v_cvt_pk_bf16_f32 v16, v16, v17
v_exp_f32 v20, v20
v_add_f32 v246, v246, v18
v_exp_f32 v21, v21
v_add_f32 v246, v246, v19
v_cvt_pk_bf16_f32 v17, v18, v19
v_exp_f32 v22, v22
v_add_f32 v246, v246, v20
v_exp_f32 v23, v23
v_add_f32 v246, v246, v21
v_cvt_pk_bf16_f32 v18, v20, v21
v_add_f32 v246, v246, v22
v_add_f32 v246, v246, v23
v_cvt_pk_bf16_f32 v19, v22, v23
v_max3_f32 v0, v24, v25, v26
v_max3_f32 v0, v0, v27, v28
v_max3_f32 v0, v0, v29, v30
v_max_f32 v0, v0, v31
v_mov_b32 v1, v0
s_nop 0
s_nop 0
v_permlane16_swap_b32 v0, v1
v_max_f32 v0, v0, v1
v_mov_b32 v1, v0
s_nop 0
s_nop 0
v_permlane32_swap_b32 v0, v1
v_max_f32 v0, v0, v1
v_sub_f32 v0, 0, v0
v_cndmask_b32 v0, v0, v212, s[50:51]
v_mov_b32 v212, v0
v_mov_b32 v213, v0
v_mov_b32 v214, v0
v_mov_b32 v215, v0
v_add_f32 v24, v24, v0
v_add_f32 v25, v25, v0
v_add_f32 v26, v26, v0
v_add_f32 v27, v27, v0
v_add_f32 v28, v28, v0
v_add_f32 v29, v29, v0
v_add_f32 v30, v30, v0
v_add_f32 v31, v31, v0
v_mov_b32 v247, 0
v_exp_f32 v24, v24
v_exp_f32 v25, v25
v_exp_f32 v26, v26
v_add_f32 v247, v247, v24
v_exp_f32 v27, v27
v_add_f32 v247, v247, v25
v_cvt_pk_bf16_f32 v24, v24, v25
v_exp_f32 v28, v28
v_add_f32 v247, v247, v26
v_exp_f32 v29, v29
v_add_f32 v247, v247, v27
v_cvt_pk_bf16_f32 v25, v26, v27
v_exp_f32 v30, v30
v_add_f32 v247, v247, v28
v_exp_f32 v31, v31
v_add_f32 v247, v247, v29
v_cvt_pk_bf16_f32 v26, v28, v29
v_add_f32 v247, v247, v30
v_add_f32 v247, v247, v31
v_cvt_pk_bf16_f32 v27, v30, v31
s_waitcnt vmcnt(10)
s_waitcnt lgkmcnt(0)
s_barrier
ds_read_b128 v[144:147], v12 offset:8192
ds_read_b128 v[148:151], v13 offset:8192
ds_read_b128 v[152:155], v14 offset:8192
ds_read_b128 v[156:159], v15 offset:8192
ds_read_b128 v[160:163], v12 offset:12288
ds_read_b128 v[164:167], v13 offset:12288
ds_read_b128 v[168:171], v14 offset:12288
ds_read_b128 v[172:175], v15 offset:12288
ds_read_b128 a[224:227], v232 offset:8192
ds_read_b128 a[228:231], v233 offset:8192
ds_read_b128 a[232:235], v234 offset:8192
ds_read_b128 a[236:239], v235 offset:8192
ds_read_b128 a[240:243], v232 offset:12288
ds_read_b128 a[244:247], v233 offset:12288
ds_read_b128 a[248:251], v234 offset:12288
s_waitcnt lgkmcnt(13)
ds_read_b128 a[252:255], v235 offset:12288
s_add_u32 m0, s22, 0x8000
v_lshlrev_b32 v4, 16, v144
v_and_b32 v5, 0xffff0000, v144
buffer_load_dwordx4 v244, s[8:11], s21 offen nt lds
v_mul_f32 v4, s24, v4
v_mul_f32 v5, s24, v5
v_cvt_pk_bf16_f32 v144, v4, v5
v_lshlrev_b32 v6, 16, v145
v_and_b32 v7, 0xffff0000, v145
v_mul_f32 v6, s24, v6
v_mul_f32 v7, s24, v7
v_cvt_pk_bf16_f32 v145, v6, v7
v_lshlrev_b32 v8, 16, v146
v_and_b32 v9, 0xffff0000, v146
v_mul_f32 v8, s24, v8
v_mul_f32 v9, s24, v9
v_cvt_pk_bf16_f32 v146, v8, v9
v_lshlrev_b32 v10, 16, v147
v_and_b32 v11, 0xffff0000, v147
v_mul_f32 v10, s24, v10
v_mul_f32 v11, s24, v11
v_cvt_pk_bf16_f32 v147, v10, v11
v_lshlrev_b32 v4, 16, v148
v_and_b32 v5, 0xffff0000, v148
buffer_load_dwordx4 v244, s[8:11], s21 offen offset:2048 nt lds
s_add_u32 s21, s21, 0x2000
v_mul_f32 v4, s24, v4
v_mul_f32 v5, s24, v5
v_cvt_pk_bf16_f32 v148, v4, v5
v_lshlrev_b32 v6, 16, v149
v_and_b32 v7, 0xffff0000, v149
v_mul_f32 v6, s24, v6
v_mul_f32 v7, s24, v7
v_cvt_pk_bf16_f32 v149, v6, v7
v_lshlrev_b32 v8, 16, v150
v_and_b32 v9, 0xffff0000, v150
v_mul_f32 v8, s24, v8
v_mul_f32 v9, s24, v9
v_cvt_pk_bf16_f32 v150, v8, v9
v_lshlrev_b32 v10, 16, v151
v_and_b32 v11, 0xffff0000, v151
v_mul_f32 v10, s24, v10
v_mul_f32 v11, s24, v11
v_cvt_pk_bf16_f32 v151, v10, v11
s_add_u32 m0, s22, 0x4000
s_waitcnt lgkmcnt(13)
v_lshlrev_b32 v4, 16, v152
v_and_b32 v5, 0xffff0000, v152
buffer_load_dwordx4 v244, s[4:7], s20 offen nt lds
v_mul_f32 v4, s24, v4
v_mul_f32 v5, s24, v5
v_cvt_pk_bf16_f32 v152, v4, v5
v_lshlrev_b32 v6, 16, v153
v_and_b32 v7, 0xffff0000, v153
v_mul_f32 v6, s24, v6
v_mul_f32 v7, s24, v7
v_cvt_pk_bf16_f32 v153, v6, v7
v_lshlrev_b32 v8, 16, v154
v_and_b32 v9, 0xffff0000, v154
v_mul_f32 v8, s24, v8
v_mul_f32 v9, s24, v9
v_cvt_pk_bf16_f32 v154, v8, v9
v_lshlrev_b32 v10, 16, v155
v_and_b32 v11, 0xffff0000, v155
v_mul_f32 v10, s24, v10
v_mul_f32 v11, s24, v11
v_cvt_pk_bf16_f32 v155, v10, v11
s_waitcnt lgkmcnt(12)
v_lshlrev_b32 v4, 16, v156
v_and_b32 v5, 0xffff0000, v156
buffer_load_dwordx4 v244, s[4:7], s20 offen offset:2048 nt lds
s_add_u32 s20, s20, 0x2000
v_mul_f32 v4, s24, v4
v_mul_f32 v5, s24, v5
v_cvt_pk_bf16_f32 v156, v4, v5
v_lshlrev_b32 v6, 16, v157
v_and_b32 v7, 0xffff0000, v157
v_mul_f32 v6, s24, v6
v_mul_f32 v7, s24, v7
v_cvt_pk_bf16_f32 v157, v6, v7
v_lshlrev_b32 v8, 16, v158
v_and_b32 v9, 0xffff0000, v158
v_mul_f32 v8, s24, v8
v_mul_f32 v9, s24, v9
v_cvt_pk_bf16_f32 v158, v8, v9
v_lshlrev_b32 v10, 16, v159
v_and_b32 v11, 0xffff0000, v159
v_mul_f32 v10, s24, v10
v_mul_f32 v11, s24, v11
v_cvt_pk_bf16_f32 v159, v10, v11
s_add_u32 m0, s22, 0xa000
s_waitcnt lgkmcnt(11)
v_lshlrev_b32 v4, 16, v160
v_and_b32 v5, 0xffff0000, v160
buffer_load_dwordx4 v244, s[8:11], s21 offen nt lds
v_mul_f32 v4, s24, v4
v_mul_f32 v5, s24, v5
v_cvt_pk_bf16_f32 v160, v4, v5
v_mfma_f32_16x16x32_bf16 v[32:35], a[192:195], v[144:147], 0
v_lshlrev_b32 v6, 16, v161
v_and_b32 v7, 0xffff0000, v161
v_mul_f32 v6, s24, v6
v_mfma_f32_16x16x32_bf16 v[32:35], a[196:199], v[148:151], v[32:35]
v_mul_f32 v7, s24, v7
v_cvt_pk_bf16_f32 v161, v6, v7
v_lshlrev_b32 v8, 16, v162
v_mfma_f32_16x16x32_bf16 v[32:35], a[200:203], v[152:155], v[32:35]
v_and_b32 v9, 0xffff0000, v162
v_mul_f32 v8, s24, v8
v_mul_f32 v9, s24, v9
v_mfma_f32_16x16x32_bf16 v[32:35], a[204:207], v[156:159], v[32:35]
v_cvt_pk_bf16_f32 v162, v8, v9
v_lshlrev_b32 v10, 16, v163
v_and_b32 v11, 0xffff0000, v163
v_mfma_f32_16x16x32_bf16 v[36:39], a[208:211], v[144:147], 0
v_mul_f32 v10, s24, v10
v_mul_f32 v11, s24, v11
buffer_load_dwordx4 v244, s[8:11], s21 offen offset:2048 nt lds
s_add_u32 s21, s21, 0x2000
v_cvt_pk_bf16_f32 v163, v10, v11
v_mfma_f32_16x16x32_bf16 v[36:39], a[212:215], v[148:151], v[36:39]
s_waitcnt lgkmcnt(10)
v_lshlrev_b32 v4, 16, v164
v_and_b32 v5, 0xffff0000, v164
v_mul_f32 v4, s24, v4
v_mfma_f32_16x16x32_bf16 v[36:39], a[216:219], v[152:155], v[36:39]
v_mul_f32 v5, s24, v5
v_cvt_pk_bf16_f32 v164, v4, v5
v_lshlrev_b32 v6, 16, v165
v_mfma_f32_16x16x32_bf16 v[36:39], a[220:223], v[156:159], v[36:39]
v_and_b32 v7, 0xffff0000, v165
v_mul_f32 v6, s24, v6
v_mul_f32 v7, s24, v7
v_cvt_pk_bf16_f32 v165, v6, v7
v_lshlrev_b32 v8, 16, v166
v_and_b32 v9, 0xffff0000, v166
v_mul_f32 v8, s24, v8
v_mul_f32 v9, s24, v9
v_cvt_pk_bf16_f32 v166, v8, v9
v_lshlrev_b32 v10, 16, v167
s_add_u32 m0, s22, 0x6000
v_and_b32 v11, 0xffff0000, v167
v_mul_f32 v10, s24, v10
buffer_load_dwordx4 v244, s[4:7], s20 offen nt lds
v_mul_f32 v11, s24, v11
v_cvt_pk_bf16_f32 v167, v10, v11
s_waitcnt lgkmcnt(9)
v_lshlrev_b32 v4, 16, v168
v_and_b32 v5, 0xffff0000, v168
v_mul_f32 v4, s24, v4
v_mul_f32 v5, s24, v5
v_cvt_pk_bf16_f32 v168, v4, v5
v_lshlrev_b32 v6, 16, v169
v_and_b32 v7, 0xffff0000, v169
v_mul_f32 v6, s24, v6
v_mul_f32 v7, s24, v7
v_cvt_pk_bf16_f32 v169, v6, v7
v_lshlrev_b32 v8, 16, v170
v_and_b32 v9, 0xffff0000, v170
v_mul_f32 v8, s24, v8
v_mul_f32 v9, s24, v9
v_cvt_pk_bf16_f32 v170, v8, v9
v_lshlrev_b32 v10, 16, v171
v_and_b32 v11, 0xffff0000, v171
v_mul_f32 v10, s24, v10
v_mul_f32 v11, s24, v11
v_cvt_pk_bf16_f32 v171, v10, v11
buffer_load_dwordx4 v244, s[4:7], s20 offen offset:2048 nt lds
s_add_u32 s20, s20, 0x2000
s_waitcnt lgkmcnt(8)
v_lshlrev_b32 v4, 16, v172
v_and_b32 v5, 0xffff0000, v172
v_mul_f32 v4, s24, v4
v_mul_f32 v5, s24, v5
v_cvt_pk_bf16_f32 v172, v4, v5
v_lshlrev_b32 v6, 16, v173
v_and_b32 v7, 0xffff0000, v173
v_mul_f32 v6, s24, v6
v_mul_f32 v7, s24, v7
v_cvt_pk_bf16_f32 v173, v6, v7
v_lshlrev_b32 v8, 16, v174
v_and_b32 v9, 0xffff0000, v174
v_mul_f32 v8, s24, v8
v_mul_f32 v9, s24, v9
v_cvt_pk_bf16_f32 v174, v8, v9
v_lshlrev_b32 v10, 16, v175
v_and_b32 v11, 0xffff0000, v175
v_mul_f32 v10, s24, v10
v_mul_f32 v11, s24, v11
v_cvt_pk_bf16_f32 v175, v10, v11
v_max3_f32 v0, v32, v33, v34
v_max3_f32 v0, v0, v35, v36
v_mfma_f32_16x16x32_bf16 v[40:43], a[192:195], v[160:163], 0
v_max3_f32 v0, v0, v37, v38
v_max_f32 v0, v0, v39
v_mfma_f32_16x16x32_bf16 v[40:43], a[196:199], v[164:167], v[40:43]
v_mov_b32 v1, v0
s_nop 0
s_nop 0
v_permlane16_swap_b32 v0, v1
v_mfma_f32_16x16x32_bf16 v[40:43], a[200:203], v[168:171], v[40:43]
v_max_f32 v0, v0, v1
v_mov_b32 v1, v0
v_mfma_f32_16x16x32_bf16 v[40:43], a[204:207], v[172:175], v[40:43]
s_nop 0
v_permlane32_swap_b32 v0, v1
v_max_f32 v0, v0, v1
v_mfma_f32_16x16x32_bf16 v[44:47], a[208:211], v[160:163], 0
v_sub_f32 v0, 0, v0
v_cndmask_b32 v0, v0, v216, s[50:51]
v_mfma_f32_16x16x32_bf16 v[44:47], a[212:215], v[164:167], v[44:47]
v_mov_b32 v216, v0
v_mov_b32 v217, v0
v_mfma_f32_16x16x32_bf16 v[44:47], a[216:219], v[168:171], v[44:47]
v_mov_b32 v218, v0
v_mov_b32 v219, v0
v_mfma_f32_16x16x32_bf16 v[44:47], a[220:223], v[172:175], v[44:47]
v_add_f32 v32, v32, v0
v_add_f32 v33, v33, v0
v_add_f32 v34, v34, v0
v_add_f32 v35, v35, v0
v_add_f32 v36, v36, v0
v_add_f32 v37, v37, v0
v_add_f32 v38, v38, v0
v_add_f32 v39, v39, v0
v_mov_b32 v248, 0
v_exp_f32 v32, v32
v_exp_f32 v33, v33
v_exp_f32 v34, v34
v_add_f32 v248, v248, v32
v_exp_f32 v35, v35
v_add_f32 v248, v248, v33
v_cvt_pk_bf16_f32 v32, v32, v33
v_exp_f32 v36, v36
v_add_f32 v248, v248, v34
v_exp_f32 v37, v37
v_add_f32 v248, v248, v35
v_cvt_pk_bf16_f32 v33, v34, v35
v_exp_f32 v38, v38
v_add_f32 v248, v248, v36
v_exp_f32 v39, v39
v_add_f32 v248, v248, v37
v_cvt_pk_bf16_f32 v34, v36, v37
v_add_f32 v248, v248, v38
v_add_f32 v248, v248, v39
v_cvt_pk_bf16_f32 v35, v38, v39
v_max3_f32 v0, v40, v41, v42
v_max3_f32 v0, v0, v43, v44
v_max3_f32 v0, v0, v45, v46
s_waitcnt lgkmcnt(7)
v_mfma_f32_16x16x32_bf16 v[64:67], a[224:227], v[112:115], v[208:211]
v_max_f32 v0, v0, v47
v_mov_b32 v1, v0
s_nop 0
s_nop 0
v_permlane16_swap_b32 v0, v1
s_waitcnt lgkmcnt(6)
v_mfma_f32_16x16x32_bf16 v[64:67], a[228:231], v[116:119], v[64:67]
v_max_f32 v0, v0, v1
v_mov_b32 v1, v0
s_nop 0
s_nop 0
v_permlane32_swap_b32 v0, v1
s_waitcnt lgkmcnt(5)
v_mfma_f32_16x16x32_bf16 v[64:67], a[232:235], v[120:123], v[64:67]
v_max_f32 v0, v0, v1
v_sub_f32 v0, 0, v0
v_cndmask_b32 v0, v0, v220, s[50:51]
s_waitcnt lgkmcnt(4)
v_mfma_f32_16x16x32_bf16 v[64:67], a[236:239], v[124:127], v[64:67]
v_mov_b32 v220, v0
v_mov_b32 v221, v0
v_mov_b32 v222, v0
s_waitcnt lgkmcnt(3)
v_mfma_f32_16x16x32_bf16 v[68:71], a[240:243], v[112:115], v[208:211]
v_mov_b32 v223, v0
v_add_f32 v40, v40, v0
v_add_f32 v41, v41, v0
s_waitcnt lgkmcnt(2)
v_mfma_f32_16x16x32_bf16 v[68:71], a[244:247], v[116:119], v[68:71]
v_add_f32 v42, v42, v0
v_add_f32 v43, v43, v0
v_add_f32 v44, v44, v0
s_waitcnt lgkmcnt(1)
v_mfma_f32_16x16x32_bf16 v[68:71], a[248:251], v[120:123], v[68:71]
v_add_f32 v45, v45, v0
v_add_f32 v46, v46, v0
v_add_f32 v47, v47, v0
s_waitcnt lgkmcnt(0)
v_mfma_f32_16x16x32_bf16 v[68:71], a[252:255], v[124:127], v[68:71]
v_mov_b32 v249, 0
v_exp_f32 v40, v40
v_exp_f32 v41, v41
v_mfma_f32_16x16x32_bf16 v[72:75], a[224:227], v[128:131], v[212:215]
v_exp_f32 v42, v42
v_add_f32 v249, v249, v40
v_exp_f32 v43, v43
v_mfma_f32_16x16x32_bf16 v[72:75], a[228:231], v[132:135], v[72:75]
v_add_f32 v249, v249, v41
v_cvt_pk_bf16_f32 v40, v40, v41
v_exp_f32 v44, v44
v_mfma_f32_16x16x32_bf16 v[72:75], a[232:235], v[136:139], v[72:75]
v_add_f32 v249, v249, v42
v_exp_f32 v45, v45
v_add_f32 v249, v249, v43
v_mfma_f32_16x16x32_bf16 v[72:75], a[236:239], v[140:143], v[72:75]
v_cvt_pk_bf16_f32 v41, v42, v43
v_exp_f32 v46, v46
v_add_f32 v249, v249, v44
v_mfma_f32_16x16x32_bf16 v[76:79], a[240:243], v[128:131], v[212:215]
v_exp_f32 v47, v47
v_add_f32 v249, v249, v45
v_cvt_pk_bf16_f32 v42, v44, v45
v_mfma_f32_16x16x32_bf16 v[76:79], a[244:247], v[132:135], v[76:79]
v_add_f32 v249, v249, v46
v_add_f32 v249, v249, v47
v_cvt_pk_bf16_f32 v43, v46, v47
v_mfma_f32_16x16x32_bf16 v[76:79], a[248:251], v[136:139], v[76:79]
v_mfma_f32_16x16x32_bf16 v[76:79], a[252:255], v[140:143], v[76:79]
s_waitcnt vmcnt(8)
s_waitcnt lgkmcnt(0)
s_barrier
ds_read_b128 v[176:179], v12 offset:16384
ds_read_b128 v[180:183], v13 offset:16384
ds_read_b128 v[184:187], v14 offset:16384
ds_read_b128 v[188:191], v15 offset:16384
ds_read_b128 v[192:195], v12 offset:20480
ds_read_b128 v[196:199], v13 offset:20480
ds_read_b128 v[200:203], v14 offset:20480
ds_read_b128 v[204:207], v15 offset:20480
s_add_u32 m0, s22, 0x0
s_waitcnt lgkmcnt(7)
v_lshlrev_b32 v4, 16, v176
v_and_b32 v5, 0xffff0000, v176
buffer_load_dwordx4 v244, s[4:7], s20 offen nt lds
v_mul_f32 v4, s24, v4
v_mul_f32 v5, s24, v5
v_cvt_pk_bf16_f32 v176, v4, v5
v_lshlrev_b32 v6, 16, v177
v_and_b32 v7, 0xffff0000, v177
v_mul_f32 v6, s24, v6
v_mfma_f32_16x16x32_bf16 v[80:83], a[224:227], v[144:147], v[216:219]
v_mul_f32 v7, s24, v7
v_cvt_pk_bf16_f32 v177, v6, v7
v_lshlrev_b32 v8, 16, v178
v_and_b32 v9, 0xffff0000, v178
v_mfma_f32_16x16x32_bf16 v[80:83], a[228:231], v[148:151], v[80:83]
v_mul_f32 v8, s24, v8
v_mul_f32 v9, s24, v9
v_cvt_pk_bf16_f32 v178, v8, v9
v_lshlrev_b32 v10, 16, v179
v_mfma_f32_16x16x32_bf16 v[80:83], a[232:235], v[152:155], v[80:83]
v_and_b32 v11, 0xffff0000, v179
v_mul_f32 v10, s24, v10
v_mul_f32 v11, s24, v11
v_cvt_pk_bf16_f32 v179, v10, v11
v_mfma_f32_16x16x32_bf16 v[80:83], a[236:239], v[156:159], v[80:83]
s_waitcnt lgkmcnt(6)
v_lshlrev_b32 v4, 16, v180
v_and_b32 v5, 0xffff0000, v180
v_mul_f32 v4, s24, v4
v_mul_f32 v5, s24, v5
v_mfma_f32_16x16x32_bf16 v[84:87], a[240:243], v[144:147], v[216:219]
v_cvt_pk_bf16_f32 v180, v4, v5
v_lshlrev_b32 v6, 16, v181
v_and_b32 v7, 0xffff0000, v181
v_mul_f32 v6, s24, v6
v_mfma_f32_16x16x32_bf16 v[84:87], a[244:247], v[148:151], v[84:87]
v_mul_f32 v7, s24, v7
v_cvt_pk_bf16_f32 v181, v6, v7
v_lshlrev_b32 v8, 16, v182
v_and_b32 v9, 0xffff0000, v182
v_mfma_f32_16x16x32_bf16 v[84:87], a[248:251], v[152:155], v[84:87]
v_mul_f32 v8, s24, v8
v_mul_f32 v9, s24, v9
v_cvt_pk_bf16_f32 v182, v8, v9
v_lshlrev_b32 v10, 16, v183
v_mfma_f32_16x16x32_bf16 v[84:87], a[252:255], v[156:159], v[84:87]
v_and_b32 v11, 0xffff0000, v183
v_mul_f32 v10, s24, v10
v_mul_f32 v11, s24, v11
v_cvt_pk_bf16_f32 v183, v10, v11
v_mfma_f32_16x16x32_bf16 v[88:91], a[224:227], v[160:163], v[220:223]
s_waitcnt lgkmcnt(5)
v_lshlrev_b32 v4, 16, v184
buffer_load_dwordx4 v244, s[4:7], s20 offen offset:2048 nt lds
s_add_u32 s20, s20, 0x2000
v_and_b32 v5, 0xffff0000, v184
v_mul_f32 v4, s24, v4
v_mul_f32 v5, s24, v5
v_mfma_f32_16x16x32_bf16 v[88:91], a[228:231], v[164:167], v[88:91]
v_cvt_pk_bf16_f32 v184, v4, v5
v_lshlrev_b32 v6, 16, v185
v_and_b32 v7, 0xffff0000, v185
v_mul_f32 v6, s24, v6
v_mfma_f32_16x16x32_bf16 v[88:91], a[232:235], v[168:171], v[88:91]
v_mul_f32 v7, s24, v7
v_cvt_pk_bf16_f32 v185, v6, v7
v_lshlrev_b32 v8, 16, v186
v_and_b32 v9, 0xffff0000, v186
v_mfma_f32_16x16x32_bf16 v[88:91], a[236:239], v[172:175], v[88:91]
v_mul_f32 v8, s24, v8
v_mul_f32 v9, s24, v9
v_cvt_pk_bf16_f32 v186, v8, v9
v_lshlrev_b32 v10, 16, v187
v_mfma_f32_16x16x32_bf16 v[92:95], a[240:243], v[160:163], v[220:223]
v_and_b32 v11, 0xffff0000, v187
v_mul_f32 v10, s24, v10
v_mul_f32 v11, s24, v11
v_cvt_pk_bf16_f32 v187, v10, v11
v_mfma_f32_16x16x32_bf16 v[92:95], a[244:247], v[164:167], v[92:95]
s_waitcnt lgkmcnt(4)
v_lshlrev_b32 v4, 16, v188
v_and_b32 v5, 0xffff0000, v188
v_mul_f32 v4, s24, v4
v_mul_f32 v5, s24, v5
v_mfma_f32_16x16x32_bf16 v[92:95], a[248:251], v[168:171], v[92:95]
v_cvt_pk_bf16_f32 v188, v4, v5
v_lshlrev_b32 v6, 16, v189
v_and_b32 v7, 0xffff0000, v189
v_mul_f32 v6, s24, v6
v_mfma_f32_16x16x32_bf16 v[92:95], a[252:255], v[172:175], v[92:95]
v_mul_f32 v7, s24, v7
v_cvt_pk_bf16_f32 v189, v6, v7
v_lshlrev_b32 v8, 16, v190
v_and_b32 v9, 0xffff0000, v190
v_mul_f32 v8, s24, v8
v_mul_f32 v9, s24, v9
v_cvt_pk_bf16_f32 v190, v8, v9
v_lshlrev_b32 v10, 16, v191
v_and_b32 v11, 0xffff0000, v191
v_mul_f32 v10, s24, v10
v_mul_f32 v11, s24, v11
v_cvt_pk_bf16_f32 v191, v10, v11
s_add_u32 m0, s22, 0xc000
s_waitcnt lgkmcnt(3)
v_lshlrev_b32 v4, 16, v192
v_and_b32 v5, 0xffff0000, v192
buffer_load_dwordx4 v244, s[8:11], s21 offen nt lds
v_mul_f32 v4, s24, v4
v_mul_f32 v5, s24, v5
v_cvt_pk_bf16_f32 v192, v4, v5
v_mfma_f32_16x16x32_bf16 v[48:51], a[192:195], v[176:179], 0
v_lshlrev_b32 v6, 16, v193
v_and_b32 v7, 0xffff0000, v193
v_mul_f32 v6, s24, v6
v_mfma_f32_16x16x32_bf16 v[48:51], a[196:199], v[180:183], v[48:51]
v_mul_f32 v7, s24, v7
v_cvt_pk_bf16_f32 v193, v6, v7
v_lshlrev_b32 v8, 16, v194
v_mfma_f32_16x16x32_bf16 v[48:51], a[200:203], v[184:187], v[48:51]
v_and_b32 v9, 0xffff0000, v194
v_mul_f32 v8, s24, v8
v_mul_f32 v9, s24, v9
v_mfma_f32_16x16x32_bf16 v[48:51], a[204:207], v[188:191], v[48:51]
v_cvt_pk_bf16_f32 v194, v8, v9
v_lshlrev_b32 v10, 16, v195
v_and_b32 v11, 0xffff0000, v195
v_mfma_f32_16x16x32_bf16 v[52:55], a[208:211], v[176:179], 0
v_mul_f32 v10, s24, v10
v_mul_f32 v11, s24, v11
v_cvt_pk_bf16_f32 v195, v10, v11
v_mfma_f32_16x16x32_bf16 v[52:55], a[212:215], v[180:183], v[52:55]
s_waitcnt lgkmcnt(2)
v_lshlrev_b32 v4, 16, v196
v_and_b32 v5, 0xffff0000, v196
v_mul_f32 v4, s24, v4
v_mfma_f32_16x16x32_bf16 v[52:55], a[216:219], v[184:187], v[52:55]
v_mul_f32 v5, s24, v5
buffer_load_dwordx4 v244, s[8:11], s21 offen offset:2048 nt lds
s_add_u32 s21, s21, 0x2000
v_cvt_pk_bf16_f32 v196, v4, v5
v_lshlrev_b32 v6, 16, v197
v_mfma_f32_16x16x32_bf16 v[52:55], a[220:223], v[188:191], v[52:55]
v_and_b32 v7, 0xffff0000, v197
v_mul_f32 v6, s24, v6
v_mul_f32 v7, s24, v7
v_cvt_pk_bf16_f32 v197, v6, v7
v_lshlrev_b32 v8, 16, v198
v_and_b32 v9, 0xffff0000, v198
v_mul_f32 v8, s24, v8
v_mul_f32 v9, s24, v9
v_cvt_pk_bf16_f32 v198, v8, v9
v_lshlrev_b32 v10, 16, v199
v_and_b32 v11, 0xffff0000, v199
v_mul_f32 v10, s24, v10
v_mul_f32 v11, s24, v11
v_cvt_pk_bf16_f32 v199, v10, v11
s_waitcnt lgkmcnt(1)
v_lshlrev_b32 v4, 16, v200
v_and_b32 v5, 0xffff0000, v200
v_mul_f32 v4, s24, v4
v_mul_f32 v5, s24, v5
v_cvt_pk_bf16_f32 v200, v4, v5
v_lshlrev_b32 v6, 16, v201
v_and_b32 v7, 0xffff0000, v201
v_mul_f32 v6, s24, v6
v_mul_f32 v7, s24, v7
v_cvt_pk_bf16_f32 v201, v6, v7
v_lshlrev_b32 v8, 16, v202
v_and_b32 v9, 0xffff0000, v202
buffer_load_dword v255, v244, s[12:15], s42 offen
v_mul_f32 v8, s24, v8
v_mul_f32 v9, s24, v9
v_cvt_pk_bf16_f32 v202, v8, v9
v_lshlrev_b32 v10, 16, v203
v_and_b32 v11, 0xffff0000, v203
v_mul_f32 v10, s24, v10
v_mul_f32 v11, s24, v11
v_cvt_pk_bf16_f32 v203, v10, v11
s_waitcnt lgkmcnt(0)
v_lshlrev_b32 v4, 16, v204
v_and_b32 v5, 0xffff0000, v204
v_mul_f32 v4, s24, v4
v_mul_f32 v5, s24, v5
v_cvt_pk_bf16_f32 v204, v4, v5
v_lshlrev_b32 v6, 16, v205
v_and_b32 v7, 0xffff0000, v205
v_mul_f32 v6, s24, v6
v_mul_f32 v7, s24, v7
v_cvt_pk_bf16_f32 v205, v6, v7
v_lshlrev_b32 v8, 16, v206
v_and_b32 v9, 0xffff0000, v206
v_mul_f32 v8, s24, v8
v_mul_f32 v9, s24, v9
v_cvt_pk_bf16_f32 v206, v8, v9
v_lshlrev_b32 v10, 16, v207
v_and_b32 v11, 0xffff0000, v207
v_mul_f32 v10, s24, v10
v_mul_f32 v11, s24, v11
v_cvt_pk_bf16_f32 v207, v10, v11
v_max3_f32 v0, v48, v49, v50
v_max3_f32 v0, v0, v51, v52
v_mfma_f32_16x16x32_bf16 v[56:59], a[192:195], v[192:195], 0
v_max3_f32 v0, v0, v53, v54
v_max_f32 v0, v0, v55
v_mfma_f32_16x16x32_bf16 v[56:59], a[196:199], v[196:199], v[56:59]
v_mov_b32 v1, v0
s_nop 0
s_nop 0
v_permlane16_swap_b32 v0, v1
v_mfma_f32_16x16x32_bf16 v[56:59], a[200:203], v[200:203], v[56:59]
v_max_f32 v0, v0, v1
v_mov_b32 v1, v0
v_mfma_f32_16x16x32_bf16 v[56:59], a[204:207], v[204:207], v[56:59]
s_nop 0
v_permlane32_swap_b32 v0, v1
v_max_f32 v0, v0, v1
v_mfma_f32_16x16x32_bf16 v[60:63], a[208:211], v[192:195], 0
v_sub_f32 v0, 0, v0
v_cndmask_b32 v0, v0, v224, s[50:51]
v_mfma_f32_16x16x32_bf16 v[60:63], a[212:215], v[196:199], v[60:63]
v_mov_b32 v224, v0
v_mov_b32 v225, v0
v_mfma_f32_16x16x32_bf16 v[60:63], a[216:219], v[200:203], v[60:63]
v_mov_b32 v226, v0
v_mov_b32 v227, v0
v_mfma_f32_16x16x32_bf16 v[60:63], a[220:223], v[204:207], v[60:63]
v_add_f32 v48, v48, v0
v_add_f32 v49, v49, v0
v_add_f32 v50, v50, v0
v_add_f32 v51, v51, v0
v_add_f32 v52, v52, v0
v_add_f32 v53, v53, v0
v_add_f32 v54, v54, v0
v_add_f32 v55, v55, v0
v_mov_b32 v250, 0
v_exp_f32 v48, v48
v_exp_f32 v49, v49
v_exp_f32 v50, v50
v_add_f32 v250, v250, v48
v_exp_f32 v51, v51
v_add_f32 v250, v250, v49
v_cvt_pk_bf16_f32 v48, v48, v49
v_exp_f32 v52, v52
v_add_f32 v250, v250, v50
v_exp_f32 v53, v53
v_add_f32 v250, v250, v51
v_cvt_pk_bf16_f32 v49, v50, v51
v_exp_f32 v54, v54
v_add_f32 v250, v250, v52
v_exp_f32 v55, v55
v_add_f32 v250, v250, v53
v_cvt_pk_bf16_f32 v50, v52, v53
v_add_f32 v250, v250, v54
v_add_f32 v250, v250, v55
v_cvt_pk_bf16_f32 v51, v54, v55
s_waitcnt lgkmcnt(0) vmcnt(9)
s_barrier
ds_read_b64_tr_b16 a[192:193], v236 offset:0
ds_read_b64_tr_b16 a[194:195], v236 offset:4096
ds_read_b64_tr_b16 a[196:197], v237 offset:0
ds_read_b64_tr_b16 a[198:199], v237 offset:4096
ds_read_b64_tr_b16 a[200:201], v238 offset:0
ds_read_b64_tr_b16 a[202:203], v238 offset:4096
s_add_u32 m0, s22, 0x2000
v_max3_f32 v0, v56, v57, v58
v_max3_f32 v0, v0, v59, v60
buffer_load_dwordx4 v244, s[4:7], s20 offen nt lds
v_max3_f32 v0, v0, v61, v62
v_max_f32 v0, v0, v63
v_mov_b32 v1, v0
s_nop 0
s_nop 0
v_permlane16_swap_b32 v0, v1
v_max_f32 v0, v0, v1
v_mov_b32 v1, v0
s_nop 0
s_nop 0
v_permlane32_swap_b32 v0, v1
v_max_f32 v0, v0, v1
v_sub_f32 v0, 0, v0
v_mfma_f32_16x16x32_bf16 v[96:99], a[224:227], v[176:179], v[224:227]
v_cndmask_b32 v0, v0, v228, s[50:51]
buffer_load_dwordx4 v244, s[4:7], s20 offen offset:2048 nt lds
s_add_u32 s20, s20, 0x2000
v_mov_b32 v228, v0
v_mov_b32 v229, v0
v_mov_b32 v230, v0
ds_read_b64_tr_b16 a[204:205], v239 offset:0
v_mov_b32 v231, v0
v_mfma_f32_16x16x32_bf16 v[96:99], a[228:231], v[180:183], v[96:99]
v_add_f32 v56, v56, v0
v_add_f32 v57, v57, v0
v_add_f32 v58, v58, v0
s_add_u32 m0, s22, 0xe000
v_add_f32 v59, v59, v0
ds_read_b64_tr_b16 a[206:207], v239 offset:4096
buffer_load_dwordx4 v244, s[8:11], s21 offen nt lds
v_add_f32 v60, v60, v0
v_mfma_f32_16x16x32_bf16 v[96:99], a[232:235], v[184:187], v[96:99]
v_add_f32 v61, v61, v0
v_add_f32 v62, v62, v0
v_add_f32 v63, v63, v0
v_mov_b32 v251, 0
ds_read_b64_tr_b16 a[208:209], v240 offset:0
v_exp_f32 v56, v56
v_mfma_f32_16x16x32_bf16 v[96:99], a[236:239], v[188:191], v[96:99]
v_exp_f32 v57, v57
v_exp_f32 v58, v58
buffer_load_dwordx4 v244, s[8:11], s21 offen offset:2048 nt lds
s_add_u32 s21, s21, 0x2000
v_add_f32 v251, v251, v56
v_exp_f32 v59, v59
ds_read_b64_tr_b16 a[210:211], v240 offset:4096
v_add_f32 v251, v251, v57
v_mfma_f32_16x16x32_bf16 v[100:103], a[240:243], v[176:179], v[224:227]
v_cvt_pk_bf16_f32 v56, v56, v57
v_exp_f32 v60, v60
v_add_f32 v251, v251, v58
v_exp_f32 v61, v61
ds_read_b64_tr_b16 a[212:213], v241 offset:0
v_add_f32 v251, v251, v59
buffer_load_dword v255, v244, s[12:15], s42 offen
v_mfma_f32_16x16x32_bf16 v[100:103], a[244:247], v[180:183], v[100:103]
v_cvt_pk_bf16_f32 v57, v58, v59
v_exp_f32 v62, v62
v_add_f32 v251, v251, v60
v_exp_f32 v63, v63
ds_read_b64_tr_b16 a[214:215], v241 offset:4096
v_add_f32 v251, v251, v61
v_mfma_f32_16x16x32_bf16 v[100:103], a[248:251], v[184:187], v[100:103]
v_cvt_pk_bf16_f32 v58, v60, v61
v_add_f32 v251, v251, v62
v_add_f32 v251, v251, v63
v_cvt_pk_bf16_f32 v59, v62, v63
v_mfma_f32_16x16x32_bf16 v[100:103], a[252:255], v[188:191], v[100:103]
v_mfma_f32_16x16x32_bf16 v[104:107], a[224:227], v[192:195], v[228:231]
v_mfma_f32_16x16x32_bf16 v[104:107], a[228:231], v[196:199], v[104:107]
v_mfma_f32_16x16x32_bf16 v[104:107], a[232:235], v[200:203], v[104:107]
v_mfma_f32_16x16x32_bf16 v[104:107], a[236:239], v[204:207], v[104:107]
v_mfma_f32_16x16x32_bf16 v[108:111], a[240:243], v[192:195], v[228:231]
v_mfma_f32_16x16x32_bf16 v[108:111], a[244:247], v[196:199], v[108:111]
v_mfma_f32_16x16x32_bf16 v[108:111], a[248:251], v[200:203], v[108:111]
v_mfma_f32_16x16x32_bf16 v[108:111], a[252:255], v[204:207], v[108:111]
s_waitcnt lgkmcnt(10)
s_add_u32 s38, s38, 0x18000
s_cmp_lg_u32 s44, 1
s_cbranch_scc1 L_it0
s_waitcnt vmcnt(0) lgkmcnt(0)
s_barrier
v_mov_b32 v246, 0xff800000
v_mov_b32 v247, 0xff800000
v_mov_b32 v248, 0xff800000
v_mov_b32 v249, 0xff800000
v_mov_b32 v250, 0xff800000
v_mov_b32 v251, 0xff800000
s_lshl_b32 s48, s39, 18
s_mov_b32 s49, 0
v_add_u32 v0, 0x10000, v232
v_add_u32 v1, 0x10000, v233
v_add_u32 v2, 0x10000, v234
v_add_u32 v3, 0x10000, v235
L_pp:
s_add_u32 m0, s22, 0x10000
s_nop 0
buffer_load_dwordx4 v244, s[4:7], s48 offen lds
buffer_load_dwordx4 v244, s[4:7], s48 offen offset:2048 lds
s_waitcnt vmcnt(0)
s_barrier
ds_read_b128 a[192:195], v0 offset:0
ds_read_b128 a[196:199], v1 offset:0
ds_read_b128 a[200:203], v2 offset:0
ds_read_b128 a[204:207], v3 offset:0
ds_read_b128 a[208:211], v0 offset:4096
ds_read_b128 a[212:215], v1 offset:4096
ds_read_b128 a[216:219], v2 offset:4096
ds_read_b128 a[220:223], v3 offset:4096
s_waitcnt lgkmcnt(0)
v_mfma_f32_16x16x32_bf16 v[16:19], a[192:195], v[112:115], 0
v_mfma_f32_16x16x32_bf16 v[24:27], a[192:195], v[128:131], 0
v_mfma_f32_16x16x32_bf16 v[32:35], a[192:195], v[144:147], 0
v_mfma_f32_16x16x32_bf16 v[40:43], a[192:195], v[160:163], 0
v_mfma_f32_16x16x32_bf16 v[48:51], a[192:195], v[176:179], 0
v_mfma_f32_16x16x32_bf16 v[56:59], a[192:195], v[192:195], 0
v_mfma_f32_16x16x32_bf16 v[16:19], a[196:199], v[116:119], v[16:19]
v_mfma_f32_16x16x32_bf16 v[24:27], a[196:199], v[132:135], v[24:27]
v_mfma_f32_16x16x32_bf16 v[32:35], a[196:199], v[148:151], v[32:35]
v_mfma_f32_16x16x32_bf16 v[40:43], a[196:199], v[164:167], v[40:43]
v_mfma_f32_16x16x32_bf16 v[48:51], a[196:199], v[180:183], v[48:51]
v_mfma_f32_16x16x32_bf16 v[56:59], a[196:199], v[196:199], v[56:59]
v_mfma_f32_16x16x32_bf16 v[16:19], a[200:203], v[120:123], v[16:19]
v_mfma_f32_16x16x32_bf16 v[24:27], a[200:203], v[136:139], v[24:27]
v_mfma_f32_16x16x32_bf16 v[32:35], a[200:203], v[152:155], v[32:35]
v_mfma_f32_16x16x32_bf16 v[40:43], a[200:203], v[168:171], v[40:43]
v_mfma_f32_16x16x32_bf16 v[48:51], a[200:203], v[184:187], v[48:51]
v_mfma_f32_16x16x32_bf16 v[56:59], a[200:203], v[200:203], v[56:59]
v_mfma_f32_16x16x32_bf16 v[16:19], a[204:207], v[124:127], v[16:19]
v_mfma_f32_16x16x32_bf16 v[24:27], a[204:207], v[140:143], v[24:27]
v_mfma_f32_16x16x32_bf16 v[32:35], a[204:207], v[156:159], v[32:35]
v_mfma_f32_16x16x32_bf16 v[40:43], a[204:207], v[172:175], v[40:43]
v_mfma_f32_16x16x32_bf16 v[48:51], a[204:207], v[188:191], v[48:51]
v_mfma_f32_16x16x32_bf16 v[56:59], a[204:207], v[204:207], v[56:59]
v_mfma_f32_16x16x32_bf16 v[20:23], a[208:211], v[112:115], 0
v_mfma_f32_16x16x32_bf16 v[28:31], a[208:211], v[128:131], 0
v_mfma_f32_16x16x32_bf16 v[36:39], a[208:211], v[144:147], 0
v_mfma_f32_16x16x32_bf16 v[44:47], a[208:211], v[160:163], 0
v_mfma_f32_16x16x32_bf16 v[52:55], a[208:211], v[176:179], 0
v_mfma_f32_16x16x32_bf16 v[60:63], a[208:211], v[192:195], 0
v_mfma_f32_16x16x32_bf16 v[20:23], a[212:215], v[116:119], v[20:23]
v_mfma_f32_16x16x32_bf16 v[28:31], a[212:215], v[132:135], v[28:31]
v_mfma_f32_16x16x32_bf16 v[36:39], a[212:215], v[148:151], v[36:39]
v_mfma_f32_16x16x32_bf16 v[44:47], a[212:215], v[164:167], v[44:47]
v_mfma_f32_16x16x32_bf16 v[52:55], a[212:215], v[180:183], v[52:55]
v_mfma_f32_16x16x32_bf16 v[60:63], a[212:215], v[196:199], v[60:63]
v_mfma_f32_16x16x32_bf16 v[20:23], a[216:219], v[120:123], v[20:23]
v_mfma_f32_16x16x32_bf16 v[28:31], a[216:219], v[136:139], v[28:31]
v_mfma_f32_16x16x32_bf16 v[36:39], a[216:219], v[152:155], v[36:39]
v_mfma_f32_16x16x32_bf16 v[44:47], a[216:219], v[168:171], v[44:47]
v_mfma_f32_16x16x32_bf16 v[52:55], a[216:219], v[184:187], v[52:55]
v_mfma_f32_16x16x32_bf16 v[60:63], a[216:219], v[200:203], v[60:63]
v_mfma_f32_16x16x32_bf16 v[20:23], a[220:223], v[124:127], v[20:23]
v_mfma_f32_16x16x32_bf16 v[28:31], a[220:223], v[140:143], v[28:31]
v_mfma_f32_16x16x32_bf16 v[36:39], a[220:223], v[156:159], v[36:39]
v_mfma_f32_16x16x32_bf16 v[44:47], a[220:223], v[172:175], v[44:47]
v_mfma_f32_16x16x32_bf16 v[52:55], a[220:223], v[188:191], v[52:55]
v_mfma_f32_16x16x32_bf16 v[60:63], a[220:223], v[204:207], v[60:63]
s_nop 7
s_barrier
v_max3_f32 v246, v246, v16, v17
v_max_f32 v246, v246, v18
v_max3_f32 v246, v246, v19, v20
v_max3_f32 v246, v246, v21, v22
v_max_f32 v246, v246, v23
v_max3_f32 v247, v247, v24, v25
v_max_f32 v247, v247, v26
v_max3_f32 v247, v247, v27, v28
v_max3_f32 v247, v247, v29, v30
v_max_f32 v247, v247, v31
v_max3_f32 v248, v248, v32, v33
v_max_f32 v248, v248, v34
v_max3_f32 v248, v248, v35, v36
v_max3_f32 v248, v248, v37, v38
v_max_f32 v248, v248, v39
v_max3_f32 v249, v249, v40, v41
v_max_f32 v249, v249, v42
v_max3_f32 v249, v249, v43, v44
v_max3_f32 v249, v249, v45, v46
v_max_f32 v249, v249, v47
v_max3_f32 v250, v250, v48, v49
v_max_f32 v250, v250, v50
v_max3_f32 v250, v250, v51, v52
v_max3_f32 v250, v250, v53, v54
v_max_f32 v250, v250, v55
v_max3_f32 v251, v251, v56, v57
v_max_f32 v251, v251, v58
v_max3_f32 v251, v251, v59, v60
v_max3_f32 v251, v251, v61, v62
v_max_f32 v251, v251, v63
s_add_u32 s48, s48, 0x2000
s_add_u32 s49, s49, 1
s_cmp_lt_u32 s49, 32
s_cbranch_scc1 L_pp
v_mov_b32 v8, v246
v_mov_b32 v9, v247
v_mov_b32 v10, v248
v_mov_b32 v11, v249
v_mov_b32 v12, v250
v_mov_b32 v13, v251
s_nop 0
v_permlane16_swap_b32 v246, v8
v_permlane16_swap_b32 v247, v9
v_permlane16_swap_b32 v248, v10
v_permlane16_swap_b32 v249, v11
v_permlane16_swap_b32 v250, v12
v_permlane16_swap_b32 v251, v13
s_nop 0
v_max_f32 v246, v246, v8
v_max_f32 v247, v247, v9
v_max_f32 v248, v248, v10
v_max_f32 v249, v249, v11
v_max_f32 v250, v250, v12
v_max_f32 v251, v251, v13
v_mov_b32 v8, v246
v_mov_b32 v9, v247
v_mov_b32 v10, v248
v_mov_b32 v11, v249
v_mov_b32 v12, v250
v_mov_b32 v13, v251
s_nop 0
v_permlane32_swap_b32 v246, v8
v_permlane32_swap_b32 v247, v9
v_permlane32_swap_b32 v248, v10
v_permlane32_swap_b32 v249, v11
v_permlane32_swap_b32 v250, v12
v_permlane32_swap_b32 v251, v13
s_nop 0
v_max_f32 v246, v246, v8
v_max_f32 v247, v247, v9
v_max_f32 v248, v248, v10
v_max_f32 v249, v249, v11
v_max_f32 v250, v250, v12
v_max_f32 v251, v251, v13
v_sub_f32 v208, 0, v246
v_sub_f32 v212, 0, v247
v_sub_f32 v216, 0, v248
v_sub_f32 v220, 0, v249
v_sub_f32 v224, 0, v250
v_sub_f32 v228, 0, v251
s_mov_b32 s44, 2
s_mov_b64 s[50:51], -1
s_waitcnt vmcnt(0) lgkmcnt(0)
s_barrier
s_branch L_cold
L_body:
s_waitcnt lgkmcnt(0)
v_mfma_f32_16x16x32_bf16 v[64:67], a[224:227], v[112:115], v[208:211]
v_mfma_f32_16x16x32_bf16 v[64:67], a[228:231], v[116:119], v[64:67]
v_mfma_f32_16x16x32_bf16 v[64:67], a[232:235], v[120:123], v[64:67]
v_max3_f32 v0, v56, v57, v58
v_mfma_f32_16x16x32_bf16 v[64:67], a[236:239], v[124:127], v[64:67]
s_nop 0
s_nop 0
v_max3_f32 v0, v0, v59, v60
v_mfma_f32_16x16x32_bf16 v[68:71], a[240:243], v[112:115], v[208:211]
v_max3_f32 v0, v0, v61, v62
v_mfma_f32_16x16x32_bf16 v[68:71], a[244:247], v[116:119], v[68:71]
v_max_f32 v0, v0, v63
v_mfma_f32_16x16x32_bf16 v[68:71], a[248:251], v[120:123], v[68:71]
v_mov_b32 v1, v0
v_mfma_f32_16x16x32_bf16 v[68:71], a[252:255], v[124:127], v[68:71]
s_nop 0
v_permlane16_swap_b32 v0, v1
v_mfma_f32_16x16x32_bf16 v[72:75], a[224:227], v[128:131], v[212:215]
v_max_f32 v0, v0, v1
v_mfma_f32_16x16x32_bf16 v[72:75], a[228:231], v[132:135], v[72:75]
v_mov_b32 v1, v0
v_mfma_f32_16x16x32_bf16 v[72:75], a[232:235], v[136:139], v[72:75]
s_nop 0
v_permlane32_swap_b32 v0, v1
v_mfma_f32_16x16x32_bf16 v[72:75], a[236:239], v[140:143], v[72:75]
v_max_f32 v0, v0, v1
v_mfma_f32_16x16x32_bf16 v[76:79], a[240:243], v[128:131], v[212:215]
s_waitcnt lgkmcnt(0) vmcnt(13)
s_barrier
v_sub_f32 v0, 0, v0
v_mfma_f32_16x16x32_bf16 v[76:79], a[244:247], v[132:135], v[76:79]
ds_read_b64_tr_b16 a[192:193], v236 offset:0
v_cndmask_b32 v0, v0, v228, s[50:51]
v_mov_b32 v228, v0
v_mfma_f32_16x16x32_bf16 v[76:79], a[248:251], v[136:139], v[76:79]
s_add_u32 m0, s22, 0x2000
v_mov_b32 v229, v0
v_mov_b32 v230, v0
v_mfma_f32_16x16x32_bf16 v[76:79], a[252:255], v[140:143], v[76:79]
ds_read_b64_tr_b16 a[194:195], v236 offset:4096
buffer_load_dwordx4 v244, s[4:7], s20 offen nt lds
buffer_load_dwordx4 v244, s[4:7], s20 offen offset:2048 nt lds
v_mov_b32 v231, v0
v_add_f32 v56, v56, v0
v_mfma_f32_16x16x32_bf16 v[80:83], a[224:227], v[144:147], v[216:219]
s_add_u32 s20, s20, 0x2000
v_add_f32 v57, v57, v0
v_add_f32 v58, v58, v0
v_mfma_f32_16x16x32_bf16 v[80:83], a[228:231], v[148:151], v[80:83]
v_add_f32 v59, v59, v0
v_add_f32 v60, v60, v0
v_mfma_f32_16x16x32_bf16 v[80:83], a[232:235], v[152:155], v[80:83]
ds_read_b64_tr_b16 a[196:197], v237 offset:0
v_add_f32 v61, v61, v0
v_add_f32 v62, v62, v0
v_mfma_f32_16x16x32_bf16 v[80:83], a[236:239], v[156:159], v[80:83]
v_add_f32 v63, v63, v0
v_mov_b32 v251, 0
v_mfma_f32_16x16x32_bf16 v[84:87], a[240:243], v[144:147], v[216:219]
s_add_u32 m0, s22, 0xe000
v_exp_f32 v56, v56
v_mfma_f32_16x16x32_bf16 v[84:87], a[244:247], v[148:151], v[84:87]
ds_read_b64_tr_b16 a[198:199], v237 offset:4096
buffer_load_dwordx4 v244, s[8:11], s21 offen nt lds
buffer_load_dwordx4 v244, s[8:11], s21 offen offset:2048 nt lds
v_exp_f32 v57, v57
v_mfma_f32_16x16x32_bf16 v[84:87], a[248:251], v[152:155], v[84:87]
s_add_u32 s21, s21, 0x2000
v_exp_f32 v58, v58
v_mfma_f32_16x16x32_bf16 v[84:87], a[252:255], v[156:159], v[84:87]
v_add_f32 v251, v251, v56
v_exp_f32 v59, v59
v_mfma_f32_16x16x32_bf16 v[88:91], a[224:227], v[160:163], v[220:223]
ds_read_b64_tr_b16 a[200:201], v238 offset:0
v_add_f32 v251, v251, v57
v_cvt_pk_bf16_f32 v56, v56, v57
v_mfma_f32_16x16x32_bf16 v[88:91], a[228:231], v[164:167], v[88:91]
buffer_load_dword v255, v244, s[12:15], s42 offen
v_exp_f32 v60, v60
v_mfma_f32_16x16x32_bf16 v[88:91], a[232:235], v[168:171], v[88:91]
ds_read_b64_tr_b16 a[202:203], v238 offset:4096
v_add_f32 v251, v251, v58
v_exp_f32 v61, v61
v_mfma_f32_16x16x32_bf16 v[88:91], a[236:239], v[172:175], v[88:91]
v_add_f32 v251, v251, v59
v_cvt_pk_bf16_f32 v57, v58, v59
v_mfma_f32_16x16x32_bf16 v[92:95], a[240:243], v[160:163], v[220:223]
v_exp_f32 v62, v62
v_mfma_f32_16x16x32_bf16 v[92:95], a[244:247], v[164:167], v[92:95]
ds_read_b64_tr_b16 a[204:205], v239 offset:0
v_add_f32 v251, v251, v60
v_exp_f32 v63, v63
v_mfma_f32_16x16x32_bf16 v[92:95], a[248:251], v[168:171], v[92:95]
v_add_f32 v251, v251, v61
v_cvt_pk_bf16_f32 v58, v60, v61
v_mfma_f32_16x16x32_bf16 v[92:95], a[252:255], v[172:175], v[92:95]
v_add_f32 v251, v251, v62
v_add_f32 v251, v251, v63
v_mfma_f32_16x16x32_bf16 v[96:99], a[224:227], v[176:179], v[224:227]
ds_read_b64_tr_b16 a[206:207], v239 offset:4096
v_cvt_pk_bf16_f32 v59, v62, v63
v_mfma_f32_16x16x32_bf16 v[96:99], a[228:231], v[180:183], v[96:99]
v_mfma_f32_16x16x32_bf16 v[96:99], a[232:235], v[184:187], v[96:99]
v_mfma_f32_16x16x32_bf16 v[96:99], a[236:239], v[188:191], v[96:99]
ds_read_b64_tr_b16 a[208:209], v240 offset:0
v_mfma_f32_16x16x32_bf16 v[100:103], a[240:243], v[176:179], v[224:227]
v_mfma_f32_16x16x32_bf16 v[100:103], a[244:247], v[180:183], v[100:103]
ds_read_b64_tr_b16 a[210:211], v240 offset:4096
v_mfma_f32_16x16x32_bf16 v[100:103], a[248:251], v[184:187], v[100:103]
v_mfma_f32_16x16x32_bf16 v[100:103], a[252:255], v[188:191], v[100:103]
v_mfma_f32_16x16x32_bf16 v[104:107], a[224:227], v[192:195], v[228:231]
ds_read_b64_tr_b16 a[212:213], v241 offset:0
v_mfma_f32_16x16x32_bf16 v[104:107], a[228:231], v[196:199], v[104:107]
v_mfma_f32_16x16x32_bf16 v[104:107], a[232:235], v[200:203], v[104:107]
v_mfma_f32_16x16x32_bf16 v[104:107], a[236:239], v[204:207], v[104:107]
ds_read_b64_tr_b16 a[214:215], v241 offset:4096
v_mfma_f32_16x16x32_bf16 v[108:111], a[240:243], v[192:195], v[228:231]
v_mfma_f32_16x16x32_bf16 v[108:111], a[244:247], v[196:199], v[108:111]
v_mfma_f32_16x16x32_bf16 v[108:111], a[248:251], v[200:203], v[108:111]
v_mfma_f32_16x16x32_bf16 v[108:111], a[252:255], v[204:207], v[108:111]
s_waitcnt lgkmcnt(10)
s_nop 0
L_it0:
s_add_u32 s23, s22, 0x10000
s_add_u32 s41, s23, 0x16000
s_add_u32 s29, s38, 0x16000
v_mfma_f32_16x16x32_bf16 a[0:3], a[192:195], v[16:19], 0
v_exp_f32 v64, v64
v_mfma_f32_16x16x32_bf16 a[32:35], a[192:195], v[24:27], 0
ds_read_b64_tr_b16 a[216:217], v242 offset:0
v_add_f32 v246, v246, v64
v_mfma_f32_16x16x32_bf16 a[64:67], a[192:195], v[32:35], 0
v_exp_f32 v65, v65
v_mfma_f32_16x16x32_bf16 a[96:99], a[192:195], v[40:43], 0
v_add_f32 v246, v246, v65
v_cvt_pk_bf16_f32 v64, v64, v65
v_mfma_f32_16x16x32_bf16 a[128:131], a[192:195], v[48:51], 0
v_exp_f32 v66, v66
v_mfma_f32_16x16x32_bf16 a[160:163], a[192:195], v[56:59], 0
s_waitcnt lgkmcnt(9)
ds_read_b64_tr_b16 a[218:219], v242 offset:4096
v_add_f32 v246, v246, v66
v_mfma_f32_16x16x32_bf16 a[4:7], a[196:199], v[16:19], 0
v_exp_f32 v67, v67
v_mfma_f32_16x16x32_bf16 a[36:39], a[196:199], v[24:27], 0
v_add_f32 v246, v246, v67
v_cvt_pk_bf16_f32 v65, v66, v67
v_mfma_f32_16x16x32_bf16 a[68:71], a[196:199], v[32:35], 0
v_exp_f32 v68, v68
v_mfma_f32_16x16x32_bf16 a[100:103], a[196:199], v[40:43], 0
ds_read_b64_tr_b16 a[220:221], v243 offset:0
v_add_f32 v246, v246, v68
v_mfma_f32_16x16x32_bf16 a[132:135], a[196:199], v[48:51], 0
v_exp_f32 v69, v69
v_mfma_f32_16x16x32_bf16 a[164:167], a[196:199], v[56:59], 0
s_waitcnt lgkmcnt(9)
v_add_f32 v246, v246, v69
v_cvt_pk_bf16_f32 v66, v68, v69
v_mfma_f32_16x16x32_bf16 a[8:11], a[200:203], v[16:19], 0
v_exp_f32 v70, v70
v_mfma_f32_16x16x32_bf16 a[40:43], a[200:203], v[24:27], 0
ds_read_b64_tr_b16 a[222:223], v243 offset:4096
v_add_f32 v246, v246, v70
v_mfma_f32_16x16x32_bf16 a[72:75], a[200:203], v[32:35], 0
v_exp_f32 v71, v71
v_mfma_f32_16x16x32_bf16 a[104:107], a[200:203], v[40:43], 0
v_add_f32 v246, v246, v71
v_cvt_pk_bf16_f32 v67, v70, v71
v_mfma_f32_16x16x32_bf16 a[136:139], a[200:203], v[48:51], 0
v_exp_f32 v72, v72
v_mfma_f32_16x16x32_bf16 a[168:171], a[200:203], v[56:59], 0
s_waitcnt lgkmcnt(8)
ds_read_b128 a[224:227], v232 offset:16384
v_add_f32 v247, v247, v72
v_mfma_f32_16x16x32_bf16 a[12:15], a[204:207], v[16:19], 0
v_exp_f32 v73, v73
v_mfma_f32_16x16x32_bf16 a[44:47], a[204:207], v[24:27], 0
ds_read_b128 a[228:231], v233 offset:16384
v_add_f32 v247, v247, v73
v_mfma_f32_16x16x32_bf16 a[76:79], a[204:207], v[32:35], 0
v_exp_f32 v74, v74
v_mfma_f32_16x16x32_bf16 a[108:111], a[204:207], v[40:43], 0
ds_read_b128 a[232:235], v234 offset:16384
v_cvt_pk_bf16_f32 v72, v72, v73
v_mfma_f32_16x16x32_bf16 a[140:143], a[204:207], v[48:51], 0
v_exp_f32 v75, v75
v_mfma_f32_16x16x32_bf16 a[172:175], a[204:207], v[56:59], 0
s_waitcnt lgkmcnt(9)
v_add_f32 v247, v247, v74
v_add_f32 v247, v247, v75
v_mfma_f32_16x16x32_bf16 a[16:19], a[208:211], v[16:19], 0
v_exp_f32 v76, v76
v_mfma_f32_16x16x32_bf16 a[48:51], a[208:211], v[24:27], 0
ds_read_b128 a[236:239], v235 offset:16384
v_cvt_pk_bf16_f32 v73, v74, v75
v_mfma_f32_16x16x32_bf16 a[80:83], a[208:211], v[32:35], 0
v_exp_f32 v77, v77
v_mfma_f32_16x16x32_bf16 a[112:115], a[208:211], v[40:43], 0
v_add_f32 v247, v247, v76
v_add_f32 v247, v247, v77
v_mfma_f32_16x16x32_bf16 a[144:147], a[208:211], v[48:51], 0
v_exp_f32 v78, v78
v_mfma_f32_16x16x32_bf16 a[176:179], a[208:211], v[56:59], 0
s_waitcnt lgkmcnt(8)
ds_read_b128 a[240:243], v232 offset:20480
v_cvt_pk_bf16_f32 v74, v76, v77
v_mfma_f32_16x16x32_bf16 a[20:23], a[212:215], v[16:19], 0
v_exp_f32 v79, v79
v_mfma_f32_16x16x32_bf16 a[52:55], a[212:215], v[24:27], 0
v_add_f32 v247, v247, v78
v_add_f32 v247, v247, v79
v_mfma_f32_16x16x32_bf16 a[84:87], a[212:215], v[32:35], 0
v_exp_f32 v80, v80
v_mfma_f32_16x16x32_bf16 a[116:119], a[212:215], v[40:43], 0
ds_read_b128 a[244:247], v233 offset:20480
v_cvt_pk_bf16_f32 v75, v78, v79
v_mfma_f32_16x16x32_bf16 a[148:151], a[212:215], v[48:51], 0
v_exp_f32 v81, v81
v_mfma_f32_16x16x32_bf16 a[180:183], a[212:215], v[56:59], 0
s_waitcnt lgkmcnt(8)
v_add_f32 v248, v248, v80
v_add_f32 v248, v248, v81
v_mfma_f32_16x16x32_bf16 a[24:27], a[216:219], v[16:19], 0
v_exp_f32 v82, v82
v_mfma_f32_16x16x32_bf16 a[56:59], a[216:219], v[24:27], 0
ds_read_b128 a[248:251], v234 offset:20480
v_cvt_pk_bf16_f32 v80, v80, v81
v_mfma_f32_16x16x32_bf16 a[88:91], a[216:219], v[32:35], 0
v_exp_f32 v83, v83
v_mfma_f32_16x16x32_bf16 a[120:123], a[216:219], v[40:43], 0
v_add_f32 v248, v248, v82
v_add_f32 v248, v248, v83
v_mfma_f32_16x16x32_bf16 a[152:155], a[216:219], v[48:51], 0
v_exp_f32 v84, v84
v_mfma_f32_16x16x32_bf16 a[184:187], a[216:219], v[56:59], 0
s_waitcnt lgkmcnt(7)
ds_read_b128 a[252:255], v235 offset:20480
v_cvt_pk_bf16_f32 v81, v82, v83
v_mfma_f32_16x16x32_bf16 a[28:31], a[220:223], v[16:19], 0
v_exp_f32 v85, v85
v_mfma_f32_16x16x32_bf16 a[60:63], a[220:223], v[24:27], 0
v_add_f32 v248, v248, v84
v_add_f32 v248, v248, v85
v_mfma_f32_16x16x32_bf16 a[92:95], a[220:223], v[32:35], 0
v_exp_f32 v86, v86
v_mfma_f32_16x16x32_bf16 a[124:127], a[220:223], v[40:43], 0
v_cvt_pk_bf16_f32 v82, v84, v85
v_add_f32 v248, v248, v86
v_mfma_f32_16x16x32_bf16 a[156:159], a[220:223], v[48:51], 0
v_exp_f32 v87, v87
v_mfma_f32_16x16x32_bf16 a[188:191], a[220:223], v[56:59], 0
s_waitcnt lgkmcnt(0)
v_add_f32 v248, v248, v87
v_cvt_pk_bf16_f32 v83, v86, v87
v_mfma_f32_16x16x32_bf16 v[16:19], a[224:227], v[112:115], v[208:211]
v_exp_f32 v88, v88
v_mfma_f32_16x16x32_bf16 v[16:19], a[228:231], v[116:119], v[16:19]
v_add_f32 v249, v249, v88
v_mfma_f32_16x16x32_bf16 v[16:19], a[232:235], v[120:123], v[16:19]
s_waitcnt lgkmcnt(0) vmcnt(10)
s_barrier
v_exp_f32 v89, v89
v_mfma_f32_16x16x32_bf16 v[16:19], a[236:239], v[124:127], v[16:19]
ds_read_b64_tr_b16 a[192:193], v236 offset:8192
v_add_f32 v249, v249, v89
v_mfma_f32_16x16x32_bf16 v[20:23], a[240:243], v[112:115], v[208:211]
v_exp_f32 v90, v90
v_mfma_f32_16x16x32_bf16 v[20:23], a[244:247], v[116:119], v[20:23]
ds_read_b64_tr_b16 a[194:195], v236 offset:12288
v_cvt_pk_bf16_f32 v88, v88, v89
v_mfma_f32_16x16x32_bf16 v[20:23], a[248:251], v[120:123], v[20:23]
s_add_u32 m0, s22, 0x4000
v_exp_f32 v91, v91
v_mfma_f32_16x16x32_bf16 v[20:23], a[252:255], v[124:127], v[20:23]
buffer_load_dwordx4 v244, s[4:7], s20 offen nt lds
v_add_f32 v249, v249, v90
v_mfma_f32_16x16x32_bf16 v[24:27], a[224:227], v[128:131], v[212:215]
v_exp_f32 v92, v92
v_mfma_f32_16x16x32_bf16 v[24:27], a[228:231], v[132:135], v[24:27]
ds_read_b64_tr_b16 a[196:197], v237 offset:8192
v_add_f32 v249, v249, v91
v_mfma_f32_16x16x32_bf16 v[24:27], a[232:235], v[136:139], v[24:27]
v_exp_f32 v93, v93
v_mfma_f32_16x16x32_bf16 v[24:27], a[236:239], v[140:143], v[24:27]
v_cvt_pk_bf16_f32 v89, v90, v91
v_add_f32 v249, v249, v92
v_mfma_f32_16x16x32_bf16 v[28:31], a[240:243], v[128:131], v[212:215]
v_exp_f32 v94, v94
v_mfma_f32_16x16x32_bf16 v[28:31], a[244:247], v[132:135], v[28:31]
ds_read_b64_tr_b16 a[198:199], v237 offset:12288
v_add_f32 v249, v249, v93
v_mfma_f32_16x16x32_bf16 v[28:31], a[248:251], v[136:139], v[28:31]
v_exp_f32 v95, v95
v_mfma_f32_16x16x32_bf16 v[28:31], a[252:255], v[140:143], v[28:31]
buffer_load_dwordx4 v244, s[4:7], s20 offen offset:2048 nt lds
v_cvt_pk_bf16_f32 v90, v92, v93
v_mfma_f32_16x16x32_bf16 v[32:35], a[224:227], v[144:147], v[216:219]
s_add_u32 s20, s20, 0x2000
v_exp_f32 v96, v96
v_mfma_f32_16x16x32_bf16 v[32:35], a[228:231], v[148:151], v[32:35]
ds_read_b64_tr_b16 a[200:201], v238 offset:8192
v_add_f32 v249, v249, v94
v_mfma_f32_16x16x32_bf16 v[32:35], a[232:235], v[152:155], v[32:35]
v_exp_f32 v97, v97
v_mfma_f32_16x16x32_bf16 v[32:35], a[236:239], v[156:159], v[32:35]
v_add_f32 v249, v249, v95
v_cvt_pk_bf16_f32 v91, v94, v95
v_mfma_f32_16x16x32_bf16 v[36:39], a[240:243], v[144:147], v[216:219]
v_exp_f32 v98, v98
v_mfma_f32_16x16x32_bf16 v[36:39], a[244:247], v[148:151], v[36:39]
ds_read_b64_tr_b16 a[202:203], v238 offset:12288
v_add_f32 v250, v250, v96
v_mfma_f32_16x16x32_bf16 v[36:39], a[248:251], v[152:155], v[36:39]
s_add_u32 m0, s22, 0x8000
v_exp_f32 v99, v99
v_mfma_f32_16x16x32_bf16 v[36:39], a[252:255], v[156:159], v[36:39]
buffer_load_dwordx4 v244, s[8:11], s21 offen nt lds
v_add_f32 v250, v250, v97
v_mfma_f32_16x16x32_bf16 v[40:43], a[224:227], v[160:163], v[220:223]
v_exp_f32 v100, v100
v_mfma_f32_16x16x32_bf16 v[40:43], a[228:231], v[164:167], v[40:43]
ds_read_b64_tr_b16 a[204:205], v239 offset:8192
v_cvt_pk_bf16_f32 v96, v96, v97
v_mfma_f32_16x16x32_bf16 v[40:43], a[232:235], v[168:171], v[40:43]
v_exp_f32 v101, v101
v_mfma_f32_16x16x32_bf16 v[40:43], a[236:239], v[172:175], v[40:43]
v_add_f32 v250, v250, v98
v_add_f32 v250, v250, v99
v_mfma_f32_16x16x32_bf16 v[44:47], a[240:243], v[160:163], v[220:223]
v_exp_f32 v102, v102
v_mfma_f32_16x16x32_bf16 v[44:47], a[244:247], v[164:167], v[44:47]
ds_read_b64_tr_b16 a[206:207], v239 offset:12288
v_cvt_pk_bf16_f32 v97, v98, v99
v_mfma_f32_16x16x32_bf16 v[44:47], a[248:251], v[168:171], v[44:47]
v_exp_f32 v103, v103
v_mfma_f32_16x16x32_bf16 v[44:47], a[252:255], v[172:175], v[44:47]
buffer_load_dwordx4 v244, s[8:11], s21 offen offset:2048 nt lds
v_add_f32 v250, v250, v100
v_mfma_f32_16x16x32_bf16 v[48:51], a[224:227], v[176:179], v[224:227]
s_add_u32 s21, s21, 0x2000
v_exp_f32 v104, v104
v_mfma_f32_16x16x32_bf16 v[48:51], a[228:231], v[180:183], v[48:51]
ds_read_b64_tr_b16 a[208:209], v240 offset:8192
v_add_f32 v250, v250, v101
v_mfma_f32_16x16x32_bf16 v[48:51], a[232:235], v[184:187], v[48:51]
v_exp_f32 v105, v105
v_mfma_f32_16x16x32_bf16 v[48:51], a[236:239], v[188:191], v[48:51]
v_cvt_pk_bf16_f32 v98, v100, v101
v_add_f32 v250, v250, v102
v_mfma_f32_16x16x32_bf16 v[52:55], a[240:243], v[176:179], v[224:227]
v_exp_f32 v106, v106
v_mfma_f32_16x16x32_bf16 v[52:55], a[244:247], v[180:183], v[52:55]
ds_read_b64_tr_b16 a[210:211], v240 offset:12288
v_add_f32 v250, v250, v103
v_mfma_f32_16x16x32_bf16 v[52:55], a[248:251], v[184:187], v[52:55]
v_exp_f32 v107, v107
v_mfma_f32_16x16x32_bf16 v[52:55], a[252:255], v[188:191], v[52:55]
buffer_load_dword v255, v244, s[12:15], s42 offen
v_cvt_pk_bf16_f32 v99, v102, v103
v_mfma_f32_16x16x32_bf16 v[56:59], a[224:227], v[192:195], v[228:231]
v_exp_f32 v108, v108
v_mfma_f32_16x16x32_bf16 v[56:59], a[228:231], v[196:199], v[56:59]
ds_read_b64_tr_b16 a[212:213], v241 offset:8192
v_add_f32 v251, v251, v104
v_mfma_f32_16x16x32_bf16 v[56:59], a[232:235], v[200:203], v[56:59]
v_exp_f32 v109, v109
v_mfma_f32_16x16x32_bf16 v[56:59], a[236:239], v[204:207], v[56:59]
v_add_f32 v251, v251, v105
v_cvt_pk_bf16_f32 v104, v104, v105
v_mfma_f32_16x16x32_bf16 v[60:63], a[240:243], v[192:195], v[228:231]
v_exp_f32 v110, v110
v_mfma_f32_16x16x32_bf16 v[60:63], a[244:247], v[196:199], v[60:63]
ds_read_b64_tr_b16 a[214:215], v241 offset:12288
v_add_f32 v251, v251, v106
v_mfma_f32_16x16x32_bf16 v[60:63], a[248:251], v[200:203], v[60:63]
v_exp_f32 v111, v111
v_mfma_f32_16x16x32_bf16 v[60:63], a[252:255], v[204:207], v[60:63]
s_waitcnt lgkmcnt(10)
v_add_f32 v251, v251, v107
v_cvt_pk_bf16_f32 v105, v106, v107
v_add_f32 v251, v251, v108
v_add_f32 v251, v251, v109
v_cvt_pk_bf16_f32 v106, v108, v109
v_add_f32 v251, v251, v110
v_add_f32 v251, v251, v111
v_cvt_pk_bf16_f32 v107, v110, v111
s_mov_b32 s28, 0
s_cmp_lg_u32 s35, 0
s_cbranch_scc1 L_loopo_pre
L_loopq:
v_mfma_f32_16x16x32_bf16 a[0:3], a[192:195], v[64:67], a[0:3]
v_exp_f32 v16, v16
v_mfma_f32_16x16x32_bf16 a[32:35], a[192:195], v[72:75], a[32:35]
ds_read_b64_tr_b16 a[216:217], v242 offset:8192
v_add_f32 v246, v246, v16
v_mfma_f32_16x16x32_bf16 a[64:67], a[192:195], v[80:83], a[64:67]
v_exp_f32 v17, v17
v_mfma_f32_16x16x32_bf16 a[96:99], a[192:195], v[88:91], a[96:99]
v_add_f32 v246, v246, v17
v_cvt_pk_bf16_f32 v16, v16, v17
v_mfma_f32_16x16x32_bf16 a[128:131], a[192:195], v[96:99], a[128:131]
v_exp_f32 v18, v18
v_mfma_f32_16x16x32_bf16 a[160:163], a[192:195], v[104:107], a[160:163]
s_waitcnt lgkmcnt(9)
ds_read_b64_tr_b16 a[218:219], v242 offset:12288
v_add_f32 v246, v246, v18
v_mfma_f32_16x16x32_bf16 a[4:7], a[196:199], v[64:67], a[4:7]
v_exp_f32 v19, v19
v_mfma_f32_16x16x32_bf16 a[36:39], a[196:199], v[72:75], a[36:39]
v_add_f32 v246, v246, v19
v_cvt_pk_bf16_f32 v17, v18, v19
v_mfma_f32_16x16x32_bf16 a[68:71], a[196:199], v[80:83], a[68:71]
v_exp_f32 v20, v20
v_mfma_f32_16x16x32_bf16 a[100:103], a[196:199], v[88:91], a[100:103]
ds_read_b64_tr_b16 a[220:221], v243 offset:8192
v_add_f32 v246, v246, v20
v_mfma_f32_16x16x32_bf16 a[132:135], a[196:199], v[96:99], a[132:135]
v_exp_f32 v21, v21
v_mfma_f32_16x16x32_bf16 a[164:167], a[196:199], v[104:107], a[164:167]
s_waitcnt lgkmcnt(9)
v_add_f32 v246, v246, v21
v_cvt_pk_bf16_f32 v18, v20, v21
v_mfma_f32_16x16x32_bf16 a[8:11], a[200:203], v[64:67], a[8:11]
v_exp_f32 v22, v22
v_mfma_f32_16x16x32_bf16 a[40:43], a[200:203], v[72:75], a[40:43]
ds_read_b64_tr_b16 a[222:223], v243 offset:12288
v_add_f32 v246, v246, v22
v_mfma_f32_16x16x32_bf16 a[72:75], a[200:203], v[80:83], a[72:75]
v_exp_f32 v23, v23
v_mfma_f32_16x16x32_bf16 a[104:107], a[200:203], v[88:91], a[104:107]
v_add_f32 v246, v246, v23
v_cvt_pk_bf16_f32 v19, v22, v23
v_mfma_f32_16x16x32_bf16 a[136:139], a[200:203], v[96:99], a[136:139]
v_exp_f32 v24, v24
v_mfma_f32_16x16x32_bf16 a[168:171], a[200:203], v[104:107], a[168:171]
s_waitcnt lgkmcnt(8)
ds_read_b128 a[224:227], v232 offset:24576
v_add_f32 v247, v247, v24
v_mfma_f32_16x16x32_bf16 a[12:15], a[204:207], v[64:67], a[12:15]
v_exp_f32 v25, v25
v_mfma_f32_16x16x32_bf16 a[44:47], a[204:207], v[72:75], a[44:47]
ds_read_b128 a[228:231], v233 offset:24576
v_add_f32 v247, v247, v25
v_mfma_f32_16x16x32_bf16 a[76:79], a[204:207], v[80:83], a[76:79]
v_exp_f32 v26, v26
v_mfma_f32_16x16x32_bf16 a[108:111], a[204:207], v[88:91], a[108:111]
ds_read_b128 a[232:235], v234 offset:24576
v_cvt_pk_bf16_f32 v24, v24, v25
v_mfma_f32_16x16x32_bf16 a[140:143], a[204:207], v[96:99], a[140:143]
v_exp_f32 v27, v27
v_mfma_f32_16x16x32_bf16 a[172:175], a[204:207], v[104:107], a[172:175]
s_waitcnt lgkmcnt(9)
v_add_f32 v247, v247, v26
v_add_f32 v247, v247, v27
v_mfma_f32_16x16x32_bf16 a[16:19], a[208:211], v[64:67], a[16:19]
v_exp_f32 v28, v28
v_mfma_f32_16x16x32_bf16 a[48:51], a[208:211], v[72:75], a[48:51]
ds_read_b128 a[236:239], v235 offset:24576
v_cvt_pk_bf16_f32 v25, v26, v27
v_mfma_f32_16x16x32_bf16 a[80:83], a[208:211], v[80:83], a[80:83]
v_exp_f32 v29, v29
v_mfma_f32_16x16x32_bf16 a[112:115], a[208:211], v[88:91], a[112:115]
v_add_f32 v247, v247, v28
v_add_f32 v247, v247, v29
v_mfma_f32_16x16x32_bf16 a[144:147], a[208:211], v[96:99], a[144:147]
v_exp_f32 v30, v30
v_mfma_f32_16x16x32_bf16 a[176:179], a[208:211], v[104:107], a[176:179]
s_waitcnt lgkmcnt(8)
ds_read_b128 a[240:243], v232 offset:28672
v_cvt_pk_bf16_f32 v26, v28, v29
v_mfma_f32_16x16x32_bf16 a[20:23], a[212:215], v[64:67], a[20:23]
v_exp_f32 v31, v31
v_mfma_f32_16x16x32_bf16 a[52:55], a[212:215], v[72:75], a[52:55]
v_add_f32 v247, v247, v30
v_add_f32 v247, v247, v31
v_mfma_f32_16x16x32_bf16 a[84:87], a[212:215], v[80:83], a[84:87]
v_exp_f32 v32, v32
v_mfma_f32_16x16x32_bf16 a[116:119], a[212:215], v[88:91], a[116:119]
ds_read_b128 a[244:247], v233 offset:28672
v_cvt_pk_bf16_f32 v27, v30, v31
v_mfma_f32_16x16x32_bf16 a[148:151], a[212:215], v[96:99], a[148:151]
v_exp_f32 v33, v33
v_mfma_f32_16x16x32_bf16 a[180:183], a[212:215], v[104:107], a[180:183]
s_waitcnt lgkmcnt(8)
v_add_f32 v248, v248, v32
v_add_f32 v248, v248, v33
v_mfma_f32_16x16x32_bf16 a[24:27], a[216:219], v[64:67], a[24:27]
v_exp_f32 v34, v34
v_mfma_f32_16x16x32_bf16 a[56:59], a[216:219], v[72:75], a[56:59]
ds_read_b128 a[248:251], v234 offset:28672
v_cvt_pk_bf16_f32 v32, v32, v33
v_mfma_f32_16x16x32_bf16 a[88:91], a[216:219], v[80:83], a[88:91]
v_exp_f32 v35, v35
v_mfma_f32_16x16x32_bf16 a[120:123], a[216:219], v[88:91], a[120:123]
v_add_f32 v248, v248, v34
v_add_f32 v248, v248, v35
v_mfma_f32_16x16x32_bf16 a[152:155], a[216:219], v[96:99], a[152:155]
v_exp_f32 v36, v36
v_mfma_f32_16x16x32_bf16 a[184:187], a[216:219], v[104:107], a[184:187]
s_waitcnt lgkmcnt(7)
ds_read_b128 a[252:255], v235 offset:28672
v_cvt_pk_bf16_f32 v33, v34, v35
v_mfma_f32_16x16x32_bf16 a[28:31], a[220:223], v[64:67], a[28:31]
v_exp_f32 v37, v37
v_mfma_f32_16x16x32_bf16 a[60:63], a[220:223], v[72:75], a[60:63]
v_add_f32 v248, v248, v36
v_add_f32 v248, v248, v37
v_mfma_f32_16x16x32_bf16 a[92:95], a[220:223], v[80:83], a[92:95]
v_exp_f32 v38, v38
v_mfma_f32_16x16x32_bf16 a[124:127], a[220:223], v[88:91], a[124:127]
v_cvt_pk_bf16_f32 v34, v36, v37
v_add_f32 v248, v248, v38
v_mfma_f32_16x16x32_bf16 a[156:159], a[220:223], v[96:99], a[156:159]
v_exp_f32 v39, v39
v_mfma_f32_16x16x32_bf16 a[188:191], a[220:223], v[104:107], a[188:191]
s_waitcnt lgkmcnt(0)
v_add_f32 v248, v248, v39
v_cvt_pk_bf16_f32 v35, v38, v39
v_mfma_f32_16x16x32_bf16 v[64:67], a[224:227], v[112:115], v[208:211]
v_exp_f32 v40, v40
v_mfma_f32_16x16x32_bf16 v[64:67], a[228:231], v[116:119], v[64:67]
v_add_f32 v249, v249, v40
v_mfma_f32_16x16x32_bf16 v[64:67], a[232:235], v[120:123], v[64:67]
s_waitcnt lgkmcnt(0) vmcnt(11)
s_barrier
v_exp_f32 v41, v41
v_mfma_f32_16x16x32_bf16 v[64:67], a[236:239], v[124:127], v[64:67]
ds_read_b64_tr_b16 a[192:193], v236 offset:16384
v_add_f32 v249, v249, v41
v_mfma_f32_16x16x32_bf16 v[68:71], a[240:243], v[112:115], v[208:211]
v_exp_f32 v42, v42
v_mfma_f32_16x16x32_bf16 v[68:71], a[244:247], v[116:119], v[68:71]
ds_read_b64_tr_b16 a[194:195], v236 offset:20480
v_cvt_pk_bf16_f32 v40, v40, v41
v_mfma_f32_16x16x32_bf16 v[68:71], a[248:251], v[120:123], v[68:71]
s_add_u32 m0, s22, 0x6000
v_exp_f32 v43, v43
v_mfma_f32_16x16x32_bf16 v[68:71], a[252:255], v[124:127], v[68:71]
buffer_load_dwordx4 v244, s[4:7], s20 offen nt lds
v_add_f32 v249, v249, v42
v_mfma_f32_16x16x32_bf16 v[72:75], a[224:227], v[128:131], v[212:215]
v_exp_f32 v44, v44
v_mfma_f32_16x16x32_bf16 v[72:75], a[228:231], v[132:135], v[72:75]
ds_read_b64_tr_b16 a[196:197], v237 offset:16384
v_add_f32 v249, v249, v43
v_mfma_f32_16x16x32_bf16 v[72:75], a[232:235], v[136:139], v[72:75]
v_exp_f32 v45, v45
v_mfma_f32_16x16x32_bf16 v[72:75], a[236:239], v[140:143], v[72:75]
v_cvt_pk_bf16_f32 v41, v42, v43
v_add_f32 v249, v249, v44
v_mfma_f32_16x16x32_bf16 v[76:79], a[240:243], v[128:131], v[212:215]
v_exp_f32 v46, v46
v_mfma_f32_16x16x32_bf16 v[76:79], a[244:247], v[132:135], v[76:79]
ds_read_b64_tr_b16 a[198:199], v237 offset:20480
v_add_f32 v249, v249, v45
v_mfma_f32_16x16x32_bf16 v[76:79], a[248:251], v[136:139], v[76:79]
v_exp_f32 v47, v47
v_mfma_f32_16x16x32_bf16 v[76:79], a[252:255], v[140:143], v[76:79]
buffer_load_dwordx4 v244, s[4:7], s20 offen offset:2048 nt lds
v_cvt_pk_bf16_f32 v42, v44, v45
v_mfma_f32_16x16x32_bf16 v[80:83], a[224:227], v[144:147], v[216:219]
s_add_u32 s20, s20, 0x2000
v_exp_f32 v48, v48
v_mfma_f32_16x16x32_bf16 v[80:83], a[228:231], v[148:151], v[80:83]
ds_read_b64_tr_b16 a[200:201], v238 offset:16384
v_add_f32 v249, v249, v46
v_mfma_f32_16x16x32_bf16 v[80:83], a[232:235], v[152:155], v[80:83]
v_exp_f32 v49, v49
v_mfma_f32_16x16x32_bf16 v[80:83], a[236:239], v[156:159], v[80:83]
v_add_f32 v249, v249, v47
v_cvt_pk_bf16_f32 v43, v46, v47
v_mfma_f32_16x16x32_bf16 v[84:87], a[240:243], v[144:147], v[216:219]
v_exp_f32 v50, v50
v_mfma_f32_16x16x32_bf16 v[84:87], a[244:247], v[148:151], v[84:87]
ds_read_b64_tr_b16 a[202:203], v238 offset:20480
v_add_f32 v250, v250, v48
v_mfma_f32_16x16x32_bf16 v[84:87], a[248:251], v[152:155], v[84:87]
s_add_u32 m0, s22, 0xa000
v_exp_f32 v51, v51
v_mfma_f32_16x16x32_bf16 v[84:87], a[252:255], v[156:159], v[84:87]
buffer_load_dwordx4 v244, s[8:11], s21 offen nt lds
v_add_f32 v250, v250, v49
v_mfma_f32_16x16x32_bf16 v[88:91], a[224:227], v[160:163], v[220:223]
v_exp_f32 v52, v52
v_mfma_f32_16x16x32_bf16 v[88:91], a[228:231], v[164:167], v[88:91]
ds_read_b64_tr_b16 a[204:205], v239 offset:16384
v_cvt_pk_bf16_f32 v48, v48, v49
v_mfma_f32_16x16x32_bf16 v[88:91], a[232:235], v[168:171], v[88:91]
v_exp_f32 v53, v53
v_mfma_f32_16x16x32_bf16 v[88:91], a[236:239], v[172:175], v[88:91]
v_add_f32 v250, v250, v50
v_add_f32 v250, v250, v51
v_mfma_f32_16x16x32_bf16 v[92:95], a[240:243], v[160:163], v[220:223]
v_exp_f32 v54, v54
v_mfma_f32_16x16x32_bf16 v[92:95], a[244:247], v[164:167], v[92:95]
ds_read_b64_tr_b16 a[206:207], v239 offset:20480
v_cvt_pk_bf16_f32 v49, v50, v51
v_mfma_f32_16x16x32_bf16 v[92:95], a[248:251], v[168:171], v[92:95]
v_exp_f32 v55, v55
v_mfma_f32_16x16x32_bf16 v[92:95], a[252:255], v[172:175], v[92:95]
buffer_load_dwordx4 v244, s[8:11], s21 offen offset:2048 nt lds
v_add_f32 v250, v250, v52
v_mfma_f32_16x16x32_bf16 v[96:99], a[224:227], v[176:179], v[224:227]
s_add_u32 s21, s21, 0x2000
v_exp_f32 v56, v56
v_mfma_f32_16x16x32_bf16 v[96:99], a[228:231], v[180:183], v[96:99]
ds_read_b64_tr_b16 a[208:209], v240 offset:16384
v_add_f32 v250, v250, v53
v_mfma_f32_16x16x32_bf16 v[96:99], a[232:235], v[184:187], v[96:99]
v_exp_f32 v57, v57
v_mfma_f32_16x16x32_bf16 v[96:99], a[236:239], v[188:191], v[96:99]
v_cvt_pk_bf16_f32 v50, v52, v53
v_add_f32 v250, v250, v54
v_mfma_f32_16x16x32_bf16 v[100:103], a[240:243], v[176:179], v[224:227]
v_exp_f32 v58, v58
v_mfma_f32_16x16x32_bf16 v[100:103], a[244:247], v[180:183], v[100:103]
ds_read_b64_tr_b16 a[210:211], v240 offset:20480
v_add_f32 v250, v250, v55
v_mfma_f32_16x16x32_bf16 v[100:103], a[248:251], v[184:187], v[100:103]
s_mov_b32 m0, s23
v_exp_f32 v59, v59
v_mfma_f32_16x16x32_bf16 v[100:103], a[252:255], v[188:191], v[100:103]
buffer_load_dwordx4 v244, s[12:15], s38 offen nt lds
v_cvt_pk_bf16_f32 v51, v54, v55
v_mfma_f32_16x16x32_bf16 v[104:107], a[224:227], v[192:195], v[228:231]
v_exp_f32 v60, v60
v_mfma_f32_16x16x32_bf16 v[104:107], a[228:231], v[196:199], v[104:107]
ds_read_b64_tr_b16 a[212:213], v241 offset:16384
v_add_f32 v251, v251, v56
v_mfma_f32_16x16x32_bf16 v[104:107], a[232:235], v[200:203], v[104:107]
v_exp_f32 v61, v61
v_mfma_f32_16x16x32_bf16 v[104:107], a[236:239], v[204:207], v[104:107]
v_add_f32 v251, v251, v57
v_cvt_pk_bf16_f32 v56, v56, v57
v_mfma_f32_16x16x32_bf16 v[108:111], a[240:243], v[192:195], v[228:231]
v_exp_f32 v62, v62
v_mfma_f32_16x16x32_bf16 v[108:111], a[244:247], v[196:199], v[108:111]
ds_read_b64_tr_b16 a[214:215], v241 offset:20480
v_add_f32 v251, v251, v58
v_mfma_f32_16x16x32_bf16 v[108:111], a[248:251], v[200:203], v[108:111]
v_exp_f32 v63, v63
v_mfma_f32_16x16x32_bf16 v[108:111], a[252:255], v[204:207], v[108:111]
s_waitcnt lgkmcnt(10)
v_add_f32 v251, v251, v59
v_cvt_pk_bf16_f32 v57, v58, v59
v_add_f32 v251, v251, v60
v_add_f32 v251, v251, v61
v_cvt_pk_bf16_f32 v58, v60, v61
v_add_f32 v251, v251, v62
v_add_f32 v251, v251, v63
v_cvt_pk_bf16_f32 v59, v62, v63
s_cmp_eq_u32 s28, 7
s_cbranch_scc1 L_tail
v_mfma_f32_16x16x32_bf16 a[0:3], a[192:195], v[16:19], a[0:3]
v_exp_f32 v64, v64
v_mfma_f32_16x16x32_bf16 a[32:35], a[192:195], v[24:27], a[32:35]
ds_read_b64_tr_b16 a[216:217], v242 offset:16384
v_add_f32 v246, v246, v64
v_mfma_f32_16x16x32_bf16 a[64:67], a[192:195], v[32:35], a[64:67]
v_exp_f32 v65, v65
v_mfma_f32_16x16x32_bf16 a[96:99], a[192:195], v[40:43], a[96:99]
v_add_f32 v246, v246, v65
v_cvt_pk_bf16_f32 v64, v64, v65
v_mfma_f32_16x16x32_bf16 a[128:131], a[192:195], v[48:51], a[128:131]
v_exp_f32 v66, v66
v_mfma_f32_16x16x32_bf16 a[160:163], a[192:195], v[56:59], a[160:163]
s_waitcnt lgkmcnt(9)
ds_read_b64_tr_b16 a[218:219], v242 offset:20480
v_add_f32 v246, v246, v66
v_mfma_f32_16x16x32_bf16 a[4:7], a[196:199], v[16:19], a[4:7]
v_exp_f32 v67, v67
v_mfma_f32_16x16x32_bf16 a[36:39], a[196:199], v[24:27], a[36:39]
v_add_f32 v246, v246, v67
v_cvt_pk_bf16_f32 v65, v66, v67
v_mfma_f32_16x16x32_bf16 a[68:71], a[196:199], v[32:35], a[68:71]
v_exp_f32 v68, v68
v_mfma_f32_16x16x32_bf16 a[100:103], a[196:199], v[40:43], a[100:103]
ds_read_b64_tr_b16 a[220:221], v243 offset:16384
v_add_f32 v246, v246, v68
v_mfma_f32_16x16x32_bf16 a[132:135], a[196:199], v[48:51], a[132:135]
v_exp_f32 v69, v69
v_mfma_f32_16x16x32_bf16 a[164:167], a[196:199], v[56:59], a[164:167]
s_waitcnt lgkmcnt(9)
v_add_f32 v246, v246, v69
v_cvt_pk_bf16_f32 v66, v68, v69
v_mfma_f32_16x16x32_bf16 a[8:11], a[200:203], v[16:19], a[8:11]
v_exp_f32 v70, v70
v_mfma_f32_16x16x32_bf16 a[40:43], a[200:203], v[24:27], a[40:43]
ds_read_b64_tr_b16 a[222:223], v243 offset:20480
v_add_f32 v246, v246, v70
v_mfma_f32_16x16x32_bf16 a[72:75], a[200:203], v[32:35], a[72:75]
v_exp_f32 v71, v71
v_mfma_f32_16x16x32_bf16 a[104:107], a[200:203], v[40:43], a[104:107]
v_add_f32 v246, v246, v71
v_cvt_pk_bf16_f32 v67, v70, v71
v_mfma_f32_16x16x32_bf16 a[136:139], a[200:203], v[48:51], a[136:139]
v_exp_f32 v72, v72
v_mfma_f32_16x16x32_bf16 a[168:171], a[200:203], v[56:59], a[168:171]
s_waitcnt lgkmcnt(8)
ds_read_b128 a[224:227], v232 offset:0
v_add_f32 v247, v247, v72
v_mfma_f32_16x16x32_bf16 a[12:15], a[204:207], v[16:19], a[12:15]
v_exp_f32 v73, v73
v_mfma_f32_16x16x32_bf16 a[44:47], a[204:207], v[24:27], a[44:47]
ds_read_b128 a[228:231], v233 offset:0
v_add_f32 v247, v247, v73
v_mfma_f32_16x16x32_bf16 a[76:79], a[204:207], v[32:35], a[76:79]
v_exp_f32 v74, v74
v_mfma_f32_16x16x32_bf16 a[108:111], a[204:207], v[40:43], a[108:111]
ds_read_b128 a[232:235], v234 offset:0
v_cvt_pk_bf16_f32 v72, v72, v73
v_mfma_f32_16x16x32_bf16 a[140:143], a[204:207], v[48:51], a[140:143]
v_exp_f32 v75, v75
v_mfma_f32_16x16x32_bf16 a[172:175], a[204:207], v[56:59], a[172:175]
s_waitcnt lgkmcnt(9)
v_add_f32 v247, v247, v74
v_add_f32 v247, v247, v75
v_mfma_f32_16x16x32_bf16 a[16:19], a[208:211], v[16:19], a[16:19]
v_exp_f32 v76, v76
v_mfma_f32_16x16x32_bf16 a[48:51], a[208:211], v[24:27], a[48:51]
ds_read_b128 a[236:239], v235 offset:0
v_cvt_pk_bf16_f32 v73, v74, v75
v_mfma_f32_16x16x32_bf16 a[80:83], a[208:211], v[32:35], a[80:83]
v_exp_f32 v77, v77
v_mfma_f32_16x16x32_bf16 a[112:115], a[208:211], v[40:43], a[112:115]
v_add_f32 v247, v247, v76
v_add_f32 v247, v247, v77
v_mfma_f32_16x16x32_bf16 a[144:147], a[208:211], v[48:51], a[144:147]
v_exp_f32 v78, v78
v_mfma_f32_16x16x32_bf16 a[176:179], a[208:211], v[56:59], a[176:179]
s_waitcnt lgkmcnt(8)
ds_read_b128 a[240:243], v232 offset:4096
v_cvt_pk_bf16_f32 v74, v76, v77
v_mfma_f32_16x16x32_bf16 a[20:23], a[212:215], v[16:19], a[20:23]
v_exp_f32 v79, v79
v_mfma_f32_16x16x32_bf16 a[52:55], a[212:215], v[24:27], a[52:55]
v_add_f32 v247, v247, v78
v_add_f32 v247, v247, v79
v_mfma_f32_16x16x32_bf16 a[84:87], a[212:215], v[32:35], a[84:87]
v_exp_f32 v80, v80
v_mfma_f32_16x16x32_bf16 a[116:119], a[212:215], v[40:43], a[116:119]
ds_read_b128 a[244:247], v233 offset:4096
v_cvt_pk_bf16_f32 v75, v78, v79
v_mfma_f32_16x16x32_bf16 a[148:151], a[212:215], v[48:51], a[148:151]
v_exp_f32 v81, v81
v_mfma_f32_16x16x32_bf16 a[180:183], a[212:215], v[56:59], a[180:183]
s_waitcnt lgkmcnt(8)
v_add_f32 v248, v248, v80
v_add_f32 v248, v248, v81
v_mfma_f32_16x16x32_bf16 a[24:27], a[216:219], v[16:19], a[24:27]
v_exp_f32 v82, v82
v_mfma_f32_16x16x32_bf16 a[56:59], a[216:219], v[24:27], a[56:59]
ds_read_b128 a[248:251], v234 offset:4096
v_cvt_pk_bf16_f32 v80, v80, v81
v_mfma_f32_16x16x32_bf16 a[88:91], a[216:219], v[32:35], a[88:91]
v_exp_f32 v83, v83
v_mfma_f32_16x16x32_bf16 a[120:123], a[216:219], v[40:43], a[120:123]
v_add_f32 v248, v248, v82
v_add_f32 v248, v248, v83
v_mfma_f32_16x16x32_bf16 a[152:155], a[216:219], v[48:51], a[152:155]
v_exp_f32 v84, v84
v_mfma_f32_16x16x32_bf16 a[184:187], a[216:219], v[56:59], a[184:187]
s_waitcnt lgkmcnt(7)
ds_read_b128 a[252:255], v235 offset:4096
v_cvt_pk_bf16_f32 v81, v82, v83
v_mfma_f32_16x16x32_bf16 a[28:31], a[220:223], v[16:19], a[28:31]
v_exp_f32 v85, v85
v_mfma_f32_16x16x32_bf16 a[60:63], a[220:223], v[24:27], a[60:63]
v_add_f32 v248, v248, v84
v_add_f32 v248, v248, v85
v_mfma_f32_16x16x32_bf16 a[92:95], a[220:223], v[32:35], a[92:95]
v_exp_f32 v86, v86
v_mfma_f32_16x16x32_bf16 a[124:127], a[220:223], v[40:43], a[124:127]
v_cvt_pk_bf16_f32 v82, v84, v85
v_add_f32 v248, v248, v86
v_mfma_f32_16x16x32_bf16 a[156:159], a[220:223], v[48:51], a[156:159]
v_exp_f32 v87, v87
v_mfma_f32_16x16x32_bf16 a[188:191], a[220:223], v[56:59], a[188:191]
s_waitcnt lgkmcnt(0)
v_add_f32 v248, v248, v87
v_cvt_pk_bf16_f32 v83, v86, v87
v_mfma_f32_16x16x32_bf16 v[16:19], a[224:227], v[112:115], v[208:211]
v_exp_f32 v88, v88
v_mfma_f32_16x16x32_bf16 v[16:19], a[228:231], v[116:119], v[16:19]
v_add_f32 v249, v249, v88
v_mfma_f32_16x16x32_bf16 v[16:19], a[232:235], v[120:123], v[16:19]
s_waitcnt lgkmcnt(0) vmcnt(11)
s_barrier
v_exp_f32 v89, v89
v_mfma_f32_16x16x32_bf16 v[16:19], a[236:239], v[124:127], v[16:19]
ds_read_b64_tr_b16 a[192:193], v236 offset:24576
v_add_f32 v249, v249, v89
v_mfma_f32_16x16x32_bf16 v[20:23], a[240:243], v[112:115], v[208:211]
v_exp_f32 v90, v90
v_mfma_f32_16x16x32_bf16 v[20:23], a[244:247], v[116:119], v[20:23]
ds_read_b64_tr_b16 a[194:195], v236 offset:28672
v_cvt_pk_bf16_f32 v88, v88, v89
v_mfma_f32_16x16x32_bf16 v[20:23], a[248:251], v[120:123], v[20:23]
s_add_u32 m0, s22, 0x0
v_exp_f32 v91, v91
v_mfma_f32_16x16x32_bf16 v[20:23], a[252:255], v[124:127], v[20:23]
buffer_load_dwordx4 v244, s[4:7], s20 offen nt lds
v_add_f32 v249, v249, v90
v_mfma_f32_16x16x32_bf16 v[24:27], a[224:227], v[128:131], v[212:215]
v_exp_f32 v92, v92
v_mfma_f32_16x16x32_bf16 v[24:27], a[228:231], v[132:135], v[24:27]
ds_read_b64_tr_b16 a[196:197], v237 offset:24576
v_add_f32 v249, v249, v91
v_mfma_f32_16x16x32_bf16 v[24:27], a[232:235], v[136:139], v[24:27]
v_exp_f32 v93, v93
v_mfma_f32_16x16x32_bf16 v[24:27], a[236:239], v[140:143], v[24:27]
v_cvt_pk_bf16_f32 v89, v90, v91
v_add_f32 v249, v249, v92
v_mfma_f32_16x16x32_bf16 v[28:31], a[240:243], v[128:131], v[212:215]
v_exp_f32 v94, v94
v_mfma_f32_16x16x32_bf16 v[28:31], a[244:247], v[132:135], v[28:31]
ds_read_b64_tr_b16 a[198:199], v237 offset:28672
v_add_f32 v249, v249, v93
v_mfma_f32_16x16x32_bf16 v[28:31], a[248:251], v[136:139], v[28:31]
v_exp_f32 v95, v95
v_mfma_f32_16x16x32_bf16 v[28:31], a[252:255], v[140:143], v[28:31]
buffer_load_dwordx4 v244, s[4:7], s20 offen offset:2048 nt lds
v_cvt_pk_bf16_f32 v90, v92, v93
v_mfma_f32_16x16x32_bf16 v[32:35], a[224:227], v[144:147], v[216:219]
s_add_u32 s20, s20, 0x2000
v_exp_f32 v96, v96
v_mfma_f32_16x16x32_bf16 v[32:35], a[228:231], v[148:151], v[32:35]
ds_read_b64_tr_b16 a[200:201], v238 offset:24576
v_add_f32 v249, v249, v94
v_mfma_f32_16x16x32_bf16 v[32:35], a[232:235], v[152:155], v[32:35]
v_exp_f32 v97, v97
v_mfma_f32_16x16x32_bf16 v[32:35], a[236:239], v[156:159], v[32:35]
v_add_f32 v249, v249, v95
v_cvt_pk_bf16_f32 v91, v94, v95
v_mfma_f32_16x16x32_bf16 v[36:39], a[240:243], v[144:147], v[216:219]
v_exp_f32 v98, v98
v_mfma_f32_16x16x32_bf16 v[36:39], a[244:247], v[148:151], v[36:39]
ds_read_b64_tr_b16 a[202:203], v238 offset:28672
v_add_f32 v250, v250, v96
v_mfma_f32_16x16x32_bf16 v[36:39], a[248:251], v[152:155], v[36:39]
s_add_u32 m0, s22, 0xc000
v_exp_f32 v99, v99
v_mfma_f32_16x16x32_bf16 v[36:39], a[252:255], v[156:159], v[36:39]
buffer_load_dwordx4 v244, s[8:11], s21 offen nt lds
v_add_f32 v250, v250, v97
v_mfma_f32_16x16x32_bf16 v[40:43], a[224:227], v[160:163], v[220:223]
v_exp_f32 v100, v100
v_mfma_f32_16x16x32_bf16 v[40:43], a[228:231], v[164:167], v[40:43]
ds_read_b64_tr_b16 a[204:205], v239 offset:24576
v_cvt_pk_bf16_f32 v96, v96, v97
v_mfma_f32_16x16x32_bf16 v[40:43], a[232:235], v[168:171], v[40:43]
v_exp_f32 v101, v101
v_mfma_f32_16x16x32_bf16 v[40:43], a[236:239], v[172:175], v[40:43]
v_add_f32 v250, v250, v98
v_add_f32 v250, v250, v99
v_mfma_f32_16x16x32_bf16 v[44:47], a[240:243], v[160:163], v[220:223]
v_exp_f32 v102, v102
v_mfma_f32_16x16x32_bf16 v[44:47], a[244:247], v[164:167], v[44:47]
ds_read_b64_tr_b16 a[206:207], v239 offset:28672
v_cvt_pk_bf16_f32 v97, v98, v99
v_mfma_f32_16x16x32_bf16 v[44:47], a[248:251], v[168:171], v[44:47]
v_exp_f32 v103, v103
v_mfma_f32_16x16x32_bf16 v[44:47], a[252:255], v[172:175], v[44:47]
buffer_load_dwordx4 v244, s[8:11], s21 offen offset:2048 nt lds
v_add_f32 v250, v250, v100
v_mfma_f32_16x16x32_bf16 v[48:51], a[224:227], v[176:179], v[224:227]
s_add_u32 s21, s21, 0x2000
v_exp_f32 v104, v104
v_mfma_f32_16x16x32_bf16 v[48:51], a[228:231], v[180:183], v[48:51]
ds_read_b64_tr_b16 a[208:209], v240 offset:24576
v_add_f32 v250, v250, v101
v_mfma_f32_16x16x32_bf16 v[48:51], a[232:235], v[184:187], v[48:51]
v_exp_f32 v105, v105
v_mfma_f32_16x16x32_bf16 v[48:51], a[236:239], v[188:191], v[48:51]
v_cvt_pk_bf16_f32 v98, v100, v101
v_add_f32 v250, v250, v102
v_mfma_f32_16x16x32_bf16 v[52:55], a[240:243], v[176:179], v[224:227]
v_exp_f32 v106, v106
v_mfma_f32_16x16x32_bf16 v[52:55], a[244:247], v[180:183], v[52:55]
ds_read_b64_tr_b16 a[210:211], v240 offset:28672
v_add_f32 v250, v250, v103
v_mfma_f32_16x16x32_bf16 v[52:55], a[248:251], v[184:187], v[52:55]
s_mov_b32 m0, s23
v_exp_f32 v107, v107
v_mfma_f32_16x16x32_bf16 v[52:55], a[252:255], v[188:191], v[52:55]
buffer_load_dwordx4 v244, s[12:15], s38 offen offset:2048 nt lds
v_cvt_pk_bf16_f32 v99, v102, v103
v_mfma_f32_16x16x32_bf16 v[56:59], a[224:227], v[192:195], v[228:231]
s_add_u32 s38, s38, 0x2000
v_exp_f32 v108, v108
v_mfma_f32_16x16x32_bf16 v[56:59], a[228:231], v[196:199], v[56:59]
ds_read_b64_tr_b16 a[212:213], v241 offset:24576
v_add_f32 v251, v251, v104
v_mfma_f32_16x16x32_bf16 v[56:59], a[232:235], v[200:203], v[56:59]
s_min_u32 s38, s38, s29
v_exp_f32 v109, v109
v_mfma_f32_16x16x32_bf16 v[56:59], a[236:239], v[204:207], v[56:59]
v_add_f32 v251, v251, v105
v_cvt_pk_bf16_f32 v104, v104, v105
v_mfma_f32_16x16x32_bf16 v[60:63], a[240:243], v[192:195], v[228:231]
s_add_u32 s23, s23, 0x2000
v_exp_f32 v110, v110
v_mfma_f32_16x16x32_bf16 v[60:63], a[244:247], v[196:199], v[60:63]
ds_read_b64_tr_b16 a[214:215], v241 offset:28672
v_add_f32 v251, v251, v106
v_mfma_f32_16x16x32_bf16 v[60:63], a[248:251], v[200:203], v[60:63]
s_min_u32 s23, s23, s41
v_exp_f32 v111, v111
v_mfma_f32_16x16x32_bf16 v[60:63], a[252:255], v[204:207], v[60:63]
s_waitcnt lgkmcnt(10)
v_add_f32 v251, v251, v107
v_cvt_pk_bf16_f32 v105, v106, v107
v_add_f32 v251, v251, v108
v_add_f32 v251, v251, v109
v_cvt_pk_bf16_f32 v106, v108, v109
v_add_f32 v251, v251, v110
v_add_f32 v251, v251, v111
v_cvt_pk_bf16_f32 v107, v110, v111
v_mfma_f32_16x16x32_bf16 a[0:3], a[192:195], v[64:67], a[0:3]
v_exp_f32 v16, v16
v_mfma_f32_16x16x32_bf16 a[32:35], a[192:195], v[72:75], a[32:35]
ds_read_b64_tr_b16 a[216:217], v242 offset:24576
v_add_f32 v246, v246, v16
v_mfma_f32_16x16x32_bf16 a[64:67], a[192:195], v[80:83], a[64:67]
v_exp_f32 v17, v17
v_mfma_f32_16x16x32_bf16 a[96:99], a[192:195], v[88:91], a[96:99]
v_add_f32 v246, v246, v17
v_cvt_pk_bf16_f32 v16, v16, v17
v_mfma_f32_16x16x32_bf16 a[128:131], a[192:195], v[96:99], a[128:131]
v_exp_f32 v18, v18
v_mfma_f32_16x16x32_bf16 a[160:163], a[192:195], v[104:107], a[160:163]
s_waitcnt lgkmcnt(9)
ds_read_b64_tr_b16 a[218:219], v242 offset:28672
v_add_f32 v246, v246, v18
v_mfma_f32_16x16x32_bf16 a[4:7], a[196:199], v[64:67], a[4:7]
v_exp_f32 v19, v19
v_mfma_f32_16x16x32_bf16 a[36:39], a[196:199], v[72:75], a[36:39]
v_add_f32 v246, v246, v19
v_cvt_pk_bf16_f32 v17, v18, v19
v_mfma_f32_16x16x32_bf16 a[68:71], a[196:199], v[80:83], a[68:71]
v_exp_f32 v20, v20
v_mfma_f32_16x16x32_bf16 a[100:103], a[196:199], v[88:91], a[100:103]
ds_read_b64_tr_b16 a[220:221], v243 offset:24576
v_add_f32 v246, v246, v20
v_mfma_f32_16x16x32_bf16 a[132:135], a[196:199], v[96:99], a[132:135]
v_exp_f32 v21, v21
v_mfma_f32_16x16x32_bf16 a[164:167], a[196:199], v[104:107], a[164:167]
s_waitcnt lgkmcnt(9)
v_add_f32 v246, v246, v21
v_cvt_pk_bf16_f32 v18, v20, v21
v_mfma_f32_16x16x32_bf16 a[8:11], a[200:203], v[64:67], a[8:11]
v_exp_f32 v22, v22
v_mfma_f32_16x16x32_bf16 a[40:43], a[200:203], v[72:75], a[40:43]
ds_read_b64_tr_b16 a[222:223], v243 offset:28672
v_add_f32 v246, v246, v22
v_mfma_f32_16x16x32_bf16 a[72:75], a[200:203], v[80:83], a[72:75]
v_exp_f32 v23, v23
v_mfma_f32_16x16x32_bf16 a[104:107], a[200:203], v[88:91], a[104:107]
v_add_f32 v246, v246, v23
v_cvt_pk_bf16_f32 v19, v22, v23
v_mfma_f32_16x16x32_bf16 a[136:139], a[200:203], v[96:99], a[136:139]
v_exp_f32 v24, v24
v_mfma_f32_16x16x32_bf16 a[168:171], a[200:203], v[104:107], a[168:171]
s_waitcnt lgkmcnt(8)
ds_read_b128 a[224:227], v232 offset:8192
v_add_f32 v247, v247, v24
v_mfma_f32_16x16x32_bf16 a[12:15], a[204:207], v[64:67], a[12:15]
v_exp_f32 v25, v25
v_mfma_f32_16x16x32_bf16 a[44:47], a[204:207], v[72:75], a[44:47]
ds_read_b128 a[228:231], v233 offset:8192
v_add_f32 v247, v247, v25
v_mfma_f32_16x16x32_bf16 a[76:79], a[204:207], v[80:83], a[76:79]
v_exp_f32 v26, v26
v_mfma_f32_16x16x32_bf16 a[108:111], a[204:207], v[88:91], a[108:111]
ds_read_b128 a[232:235], v234 offset:8192
v_cvt_pk_bf16_f32 v24, v24, v25
v_mfma_f32_16x16x32_bf16 a[140:143], a[204:207], v[96:99], a[140:143]
v_exp_f32 v27, v27
v_mfma_f32_16x16x32_bf16 a[172:175], a[204:207], v[104:107], a[172:175]
s_waitcnt lgkmcnt(9)
v_add_f32 v247, v247, v26
v_add_f32 v247, v247, v27
v_mfma_f32_16x16x32_bf16 a[16:19], a[208:211], v[64:67], a[16:19]
v_exp_f32 v28, v28
v_mfma_f32_16x16x32_bf16 a[48:51], a[208:211], v[72:75], a[48:51]
ds_read_b128 a[236:239], v235 offset:8192
v_cvt_pk_bf16_f32 v25, v26, v27
v_mfma_f32_16x16x32_bf16 a[80:83], a[208:211], v[80:83], a[80:83]
v_exp_f32 v29, v29
v_mfma_f32_16x16x32_bf16 a[112:115], a[208:211], v[88:91], a[112:115]
v_add_f32 v247, v247, v28
v_add_f32 v247, v247, v29
v_mfma_f32_16x16x32_bf16 a[144:147], a[208:211], v[96:99], a[144:147]
v_exp_f32 v30, v30
v_mfma_f32_16x16x32_bf16 a[176:179], a[208:211], v[104:107], a[176:179]
s_waitcnt lgkmcnt(8)
ds_read_b128 a[240:243], v232 offset:12288
v_cvt_pk_bf16_f32 v26, v28, v29
v_mfma_f32_16x16x32_bf16 a[20:23], a[212:215], v[64:67], a[20:23]
v_exp_f32 v31, v31
v_mfma_f32_16x16x32_bf16 a[52:55], a[212:215], v[72:75], a[52:55]
v_add_f32 v247, v247, v30
v_add_f32 v247, v247, v31
v_mfma_f32_16x16x32_bf16 a[84:87], a[212:215], v[80:83], a[84:87]
v_exp_f32 v32, v32
v_mfma_f32_16x16x32_bf16 a[116:119], a[212:215], v[88:91], a[116:119]
ds_read_b128 a[244:247], v233 offset:12288
v_cvt_pk_bf16_f32 v27, v30, v31
v_mfma_f32_16x16x32_bf16 a[148:151], a[212:215], v[96:99], a[148:151]
v_exp_f32 v33, v33
v_mfma_f32_16x16x32_bf16 a[180:183], a[212:215], v[104:107], a[180:183]
s_waitcnt lgkmcnt(8)
v_add_f32 v248, v248, v32
v_add_f32 v248, v248, v33
v_mfma_f32_16x16x32_bf16 a[24:27], a[216:219], v[64:67], a[24:27]
v_exp_f32 v34, v34
v_mfma_f32_16x16x32_bf16 a[56:59], a[216:219], v[72:75], a[56:59]
ds_read_b128 a[248:251], v234 offset:12288
v_cvt_pk_bf16_f32 v32, v32, v33
v_mfma_f32_16x16x32_bf16 a[88:91], a[216:219], v[80:83], a[88:91]
v_exp_f32 v35, v35
v_mfma_f32_16x16x32_bf16 a[120:123], a[216:219], v[88:91], a[120:123]
v_add_f32 v248, v248, v34
v_add_f32 v248, v248, v35
v_mfma_f32_16x16x32_bf16 a[152:155], a[216:219], v[96:99], a[152:155]
v_exp_f32 v36, v36
v_mfma_f32_16x16x32_bf16 a[184:187], a[216:219], v[104:107], a[184:187]
s_waitcnt lgkmcnt(7)
ds_read_b128 a[252:255], v235 offset:12288
v_cvt_pk_bf16_f32 v33, v34, v35
v_mfma_f32_16x16x32_bf16 a[28:31], a[220:223], v[64:67], a[28:31]
v_exp_f32 v37, v37
v_mfma_f32_16x16x32_bf16 a[60:63], a[220:223], v[72:75], a[60:63]
v_add_f32 v248, v248, v36
v_add_f32 v248, v248, v37
v_mfma_f32_16x16x32_bf16 a[92:95], a[220:223], v[80:83], a[92:95]
v_exp_f32 v38, v38
v_mfma_f32_16x16x32_bf16 a[124:127], a[220:223], v[88:91], a[124:127]
v_cvt_pk_bf16_f32 v34, v36, v37
v_add_f32 v248, v248, v38
v_mfma_f32_16x16x32_bf16 a[156:159], a[220:223], v[96:99], a[156:159]
v_exp_f32 v39, v39
v_mfma_f32_16x16x32_bf16 a[188:191], a[220:223], v[104:107], a[188:191]
s_waitcnt lgkmcnt(0)
v_add_f32 v248, v248, v39
v_cvt_pk_bf16_f32 v35, v38, v39
v_mfma_f32_16x16x32_bf16 v[64:67], a[224:227], v[112:115], v[208:211]
v_exp_f32 v40, v40
v_mfma_f32_16x16x32_bf16 v[64:67], a[228:231], v[116:119], v[64:67]
v_add_f32 v249, v249, v40
v_mfma_f32_16x16x32_bf16 v[64:67], a[232:235], v[120:123], v[64:67]
s_waitcnt lgkmcnt(0) vmcnt(11)
s_barrier
v_exp_f32 v41, v41
v_mfma_f32_16x16x32_bf16 v[64:67], a[236:239], v[124:127], v[64:67]
ds_read_b64_tr_b16 a[192:193], v236 offset:0
v_add_f32 v249, v249, v41
v_mfma_f32_16x16x32_bf16 v[68:71], a[240:243], v[112:115], v[208:211]
v_exp_f32 v42, v42
v_mfma_f32_16x16x32_bf16 v[68:71], a[244:247], v[116:119], v[68:71]
ds_read_b64_tr_b16 a[194:195], v236 offset:4096
v_cvt_pk_bf16_f32 v40, v40, v41
v_mfma_f32_16x16x32_bf16 v[68:71], a[248:251], v[120:123], v[68:71]
s_add_u32 m0, s22, 0x2000
v_exp_f32 v43, v43
v_mfma_f32_16x16x32_bf16 v[68:71], a[252:255], v[124:127], v[68:71]
buffer_load_dwordx4 v244, s[4:7], s20 offen nt lds
v_add_f32 v249, v249, v42
v_mfma_f32_16x16x32_bf16 v[72:75], a[224:227], v[128:131], v[212:215]
v_exp_f32 v44, v44
v_mfma_f32_16x16x32_bf16 v[72:75], a[228:231], v[132:135], v[72:75]
ds_read_b64_tr_b16 a[196:197], v237 offset:0
v_add_f32 v249, v249, v43
v_mfma_f32_16x16x32_bf16 v[72:75], a[232:235], v[136:139], v[72:75]
v_exp_f32 v45, v45
v_mfma_f32_16x16x32_bf16 v[72:75], a[236:239], v[140:143], v[72:75]
v_cvt_pk_bf16_f32 v41, v42, v43
v_add_f32 v249, v249, v44
v_mfma_f32_16x16x32_bf16 v[76:79], a[240:243], v[128:131], v[212:215]
v_exp_f32 v46, v46
v_mfma_f32_16x16x32_bf16 v[76:79], a[244:247], v[132:135], v[76:79]
ds_read_b64_tr_b16 a[198:199], v237 offset:4096
v_add_f32 v249, v249, v45
v_mfma_f32_16x16x32_bf16 v[76:79], a[248:251], v[136:139], v[76:79]
v_exp_f32 v47, v47
v_mfma_f32_16x16x32_bf16 v[76:79], a[252:255], v[140:143], v[76:79]
buffer_load_dwordx4 v244, s[4:7], s20 offen offset:2048 nt lds
v_cvt_pk_bf16_f32 v42, v44, v45
v_mfma_f32_16x16x32_bf16 v[80:83], a[224:227], v[144:147], v[216:219]
s_add_u32 s20, s20, 0x2000
v_exp_f32 v48, v48
v_mfma_f32_16x16x32_bf16 v[80:83], a[228:231], v[148:151], v[80:83]
ds_read_b64_tr_b16 a[200:201], v238 offset:0
v_add_f32 v249, v249, v46
v_mfma_f32_16x16x32_bf16 v[80:83], a[232:235], v[152:155], v[80:83]
v_exp_f32 v49, v49
v_mfma_f32_16x16x32_bf16 v[80:83], a[236:239], v[156:159], v[80:83]
v_add_f32 v249, v249, v47
v_cvt_pk_bf16_f32 v43, v46, v47
v_mfma_f32_16x16x32_bf16 v[84:87], a[240:243], v[144:147], v[216:219]
v_exp_f32 v50, v50
v_mfma_f32_16x16x32_bf16 v[84:87], a[244:247], v[148:151], v[84:87]
ds_read_b64_tr_b16 a[202:203], v238 offset:4096
v_add_f32 v250, v250, v48
v_mfma_f32_16x16x32_bf16 v[84:87], a[248:251], v[152:155], v[84:87]
s_add_u32 m0, s22, 0xe000
v_exp_f32 v51, v51
v_mfma_f32_16x16x32_bf16 v[84:87], a[252:255], v[156:159], v[84:87]
buffer_load_dwordx4 v244, s[8:11], s21 offen nt lds
v_add_f32 v250, v250, v49
v_mfma_f32_16x16x32_bf16 v[88:91], a[224:227], v[160:163], v[220:223]
v_exp_f32 v52, v52
v_mfma_f32_16x16x32_bf16 v[88:91], a[228:231], v[164:167], v[88:91]
ds_read_b64_tr_b16 a[204:205], v239 offset:0
v_cvt_pk_bf16_f32 v48, v48, v49
v_mfma_f32_16x16x32_bf16 v[88:91], a[232:235], v[168:171], v[88:91]
v_exp_f32 v53, v53
v_mfma_f32_16x16x32_bf16 v[88:91], a[236:239], v[172:175], v[88:91]
v_add_f32 v250, v250, v50
v_add_f32 v250, v250, v51
v_mfma_f32_16x16x32_bf16 v[92:95], a[240:243], v[160:163], v[220:223]
v_exp_f32 v54, v54
v_mfma_f32_16x16x32_bf16 v[92:95], a[244:247], v[164:167], v[92:95]
ds_read_b64_tr_b16 a[206:207], v239 offset:4096
v_cvt_pk_bf16_f32 v49, v50, v51
v_mfma_f32_16x16x32_bf16 v[92:95], a[248:251], v[168:171], v[92:95]
v_exp_f32 v55, v55
v_mfma_f32_16x16x32_bf16 v[92:95], a[252:255], v[172:175], v[92:95]
buffer_load_dwordx4 v244, s[8:11], s21 offen offset:2048 nt lds
v_add_f32 v250, v250, v52
v_mfma_f32_16x16x32_bf16 v[96:99], a[224:227], v[176:179], v[224:227]
s_add_u32 s21, s21, 0x2000
v_exp_f32 v56, v56
v_mfma_f32_16x16x32_bf16 v[96:99], a[228:231], v[180:183], v[96:99]
ds_read_b64_tr_b16 a[208:209], v240 offset:0
v_add_f32 v250, v250, v53
v_mfma_f32_16x16x32_bf16 v[96:99], a[232:235], v[184:187], v[96:99]
v_exp_f32 v57, v57
v_mfma_f32_16x16x32_bf16 v[96:99], a[236:239], v[188:191], v[96:99]
v_cvt_pk_bf16_f32 v50, v52, v53
v_add_f32 v250, v250, v54
v_mfma_f32_16x16x32_bf16 v[100:103], a[240:243], v[176:179], v[224:227]
v_exp_f32 v58, v58
v_mfma_f32_16x16x32_bf16 v[100:103], a[244:247], v[180:183], v[100:103]
ds_read_b64_tr_b16 a[210:211], v240 offset:4096
v_add_f32 v250, v250, v55
v_mfma_f32_16x16x32_bf16 v[100:103], a[248:251], v[184:187], v[100:103]
s_mov_b32 m0, s23
v_exp_f32 v59, v59
v_mfma_f32_16x16x32_bf16 v[100:103], a[252:255], v[188:191], v[100:103]
buffer_load_dwordx4 v244, s[12:15], s38 offen nt lds
v_cvt_pk_bf16_f32 v51, v54, v55
v_mfma_f32_16x16x32_bf16 v[104:107], a[224:227], v[192:195], v[228:231]
v_exp_f32 v60, v60
v_mfma_f32_16x16x32_bf16 v[104:107], a[228:231], v[196:199], v[104:107]
ds_read_b64_tr_b16 a[212:213], v241 offset:0
v_add_f32 v251, v251, v56
v_mfma_f32_16x16x32_bf16 v[104:107], a[232:235], v[200:203], v[104:107]
v_exp_f32 v61, v61
v_mfma_f32_16x16x32_bf16 v[104:107], a[236:239], v[204:207], v[104:107]
v_add_f32 v251, v251, v57
v_cvt_pk_bf16_f32 v56, v56, v57
v_mfma_f32_16x16x32_bf16 v[108:111], a[240:243], v[192:195], v[228:231]
v_exp_f32 v62, v62
v_mfma_f32_16x16x32_bf16 v[108:111], a[244:247], v[196:199], v[108:111]
ds_read_b64_tr_b16 a[214:215], v241 offset:4096
v_add_f32 v251, v251, v58
v_mfma_f32_16x16x32_bf16 v[108:111], a[248:251], v[200:203], v[108:111]
v_exp_f32 v63, v63
v_mfma_f32_16x16x32_bf16 v[108:111], a[252:255], v[204:207], v[108:111]
s_waitcnt lgkmcnt(10)
v_add_f32 v251, v251, v59
v_cvt_pk_bf16_f32 v57, v58, v59
v_add_f32 v251, v251, v60
v_add_f32 v251, v251, v61
v_cvt_pk_bf16_f32 v58, v60, v61
v_add_f32 v251, v251, v62
v_add_f32 v251, v251, v63
v_cvt_pk_bf16_f32 v59, v62, v63
v_mfma_f32_16x16x32_bf16 a[0:3], a[192:195], v[16:19], a[0:3]
v_exp_f32 v64, v64
v_mfma_f32_16x16x32_bf16 a[32:35], a[192:195], v[24:27], a[32:35]
ds_read_b64_tr_b16 a[216:217], v242 offset:0
v_add_f32 v246, v246, v64
v_mfma_f32_16x16x32_bf16 a[64:67], a[192:195], v[32:35], a[64:67]
v_exp_f32 v65, v65
v_mfma_f32_16x16x32_bf16 a[96:99], a[192:195], v[40:43], a[96:99]
v_add_f32 v246, v246, v65
v_cvt_pk_bf16_f32 v64, v64, v65
v_mfma_f32_16x16x32_bf16 a[128:131], a[192:195], v[48:51], a[128:131]
v_exp_f32 v66, v66
v_mfma_f32_16x16x32_bf16 a[160:163], a[192:195], v[56:59], a[160:163]
s_waitcnt lgkmcnt(9)
ds_read_b64_tr_b16 a[218:219], v242 offset:4096
v_add_f32 v246, v246, v66
v_mfma_f32_16x16x32_bf16 a[4:7], a[196:199], v[16:19], a[4:7]
v_exp_f32 v67, v67
v_mfma_f32_16x16x32_bf16 a[36:39], a[196:199], v[24:27], a[36:39]
v_add_f32 v246, v246, v67
v_cvt_pk_bf16_f32 v65, v66, v67
v_mfma_f32_16x16x32_bf16 a[68:71], a[196:199], v[32:35], a[68:71]
v_exp_f32 v68, v68
v_mfma_f32_16x16x32_bf16 a[100:103], a[196:199], v[40:43], a[100:103]
ds_read_b64_tr_b16 a[220:221], v243 offset:0
v_add_f32 v246, v246, v68
v_mfma_f32_16x16x32_bf16 a[132:135], a[196:199], v[48:51], a[132:135]
v_exp_f32 v69, v69
v_mfma_f32_16x16x32_bf16 a[164:167], a[196:199], v[56:59], a[164:167]
s_waitcnt lgkmcnt(9)
v_add_f32 v246, v246, v69
v_cvt_pk_bf16_f32 v66, v68, v69
v_mfma_f32_16x16x32_bf16 a[8:11], a[200:203], v[16:19], a[8:11]
v_exp_f32 v70, v70
v_mfma_f32_16x16x32_bf16 a[40:43], a[200:203], v[24:27], a[40:43]
ds_read_b64_tr_b16 a[222:223], v243 offset:4096
v_add_f32 v246, v246, v70
v_mfma_f32_16x16x32_bf16 a[72:75], a[200:203], v[32:35], a[72:75]
v_exp_f32 v71, v71
v_mfma_f32_16x16x32_bf16 a[104:107], a[200:203], v[40:43], a[104:107]
v_add_f32 v246, v246, v71
v_cvt_pk_bf16_f32 v67, v70, v71
v_mfma_f32_16x16x32_bf16 a[136:139], a[200:203], v[48:51], a[136:139]
v_exp_f32 v72, v72
v_mfma_f32_16x16x32_bf16 a[168:171], a[200:203], v[56:59], a[168:171]
s_waitcnt lgkmcnt(8)
ds_read_b128 a[224:227], v232 offset:16384
v_add_f32 v247, v247, v72
v_mfma_f32_16x16x32_bf16 a[12:15], a[204:207], v[16:19], a[12:15]
v_exp_f32 v73, v73
v_mfma_f32_16x16x32_bf16 a[44:47], a[204:207], v[24:27], a[44:47]
ds_read_b128 a[228:231], v233 offset:16384
v_add_f32 v247, v247, v73
v_mfma_f32_16x16x32_bf16 a[76:79], a[204:207], v[32:35], a[76:79]
v_exp_f32 v74, v74
v_mfma_f32_16x16x32_bf16 a[108:111], a[204:207], v[40:43], a[108:111]
ds_read_b128 a[232:235], v234 offset:16384
v_cvt_pk_bf16_f32 v72, v72, v73
v_mfma_f32_16x16x32_bf16 a[140:143], a[204:207], v[48:51], a[140:143]
v_exp_f32 v75, v75
v_mfma_f32_16x16x32_bf16 a[172:175], a[204:207], v[56:59], a[172:175]
s_waitcnt lgkmcnt(9)
v_add_f32 v247, v247, v74
v_add_f32 v247, v247, v75
v_mfma_f32_16x16x32_bf16 a[16:19], a[208:211], v[16:19], a[16:19]
v_exp_f32 v76, v76
v_mfma_f32_16x16x32_bf16 a[48:51], a[208:211], v[24:27], a[48:51]
ds_read_b128 a[236:239], v235 offset:16384
v_cvt_pk_bf16_f32 v73, v74, v75
v_mfma_f32_16x16x32_bf16 a[80:83], a[208:211], v[32:35], a[80:83]
v_exp_f32 v77, v77
v_mfma_f32_16x16x32_bf16 a[112:115], a[208:211], v[40:43], a[112:115]
v_add_f32 v247, v247, v76
v_add_f32 v247, v247, v77
v_mfma_f32_16x16x32_bf16 a[144:147], a[208:211], v[48:51], a[144:147]
v_exp_f32 v78, v78
v_mfma_f32_16x16x32_bf16 a[176:179], a[208:211], v[56:59], a[176:179]
s_waitcnt lgkmcnt(8)
ds_read_b128 a[240:243], v232 offset:20480
v_cvt_pk_bf16_f32 v74, v76, v77
v_mfma_f32_16x16x32_bf16 a[20:23], a[212:215], v[16:19], a[20:23]
v_exp_f32 v79, v79
v_mfma_f32_16x16x32_bf16 a[52:55], a[212:215], v[24:27], a[52:55]
v_add_f32 v247, v247, v78
v_add_f32 v247, v247, v79
v_mfma_f32_16x16x32_bf16 a[84:87], a[212:215], v[32:35], a[84:87]
v_exp_f32 v80, v80
v_mfma_f32_16x16x32_bf16 a[116:119], a[212:215], v[40:43], a[116:119]
ds_read_b128 a[244:247], v233 offset:20480
v_cvt_pk_bf16_f32 v75, v78, v79
v_mfma_f32_16x16x32_bf16 a[148:151], a[212:215], v[48:51], a[148:151]
v_exp_f32 v81, v81
v_mfma_f32_16x16x32_bf16 a[180:183], a[212:215], v[56:59], a[180:183]
s_waitcnt lgkmcnt(8)
v_add_f32 v248, v248, v80
v_add_f32 v248, v248, v81
v_mfma_f32_16x16x32_bf16 a[24:27], a[216:219], v[16:19], a[24:27]
v_exp_f32 v82, v82
v_mfma_f32_16x16x32_bf16 a[56:59], a[216:219], v[24:27], a[56:59]
ds_read_b128 a[248:251], v234 offset:20480
v_cvt_pk_bf16_f32 v80, v80, v81
v_mfma_f32_16x16x32_bf16 a[88:91], a[216:219], v[32:35], a[88:91]
v_exp_f32 v83, v83
v_mfma_f32_16x16x32_bf16 a[120:123], a[216:219], v[40:43], a[120:123]
v_add_f32 v248, v248, v82
v_add_f32 v248, v248, v83
v_mfma_f32_16x16x32_bf16 a[152:155], a[216:219], v[48:51], a[152:155]
v_exp_f32 v84, v84
v_mfma_f32_16x16x32_bf16 a[184:187], a[216:219], v[56:59], a[184:187]
s_waitcnt lgkmcnt(7)
ds_read_b128 a[252:255], v235 offset:20480
v_cvt_pk_bf16_f32 v81, v82, v83
v_mfma_f32_16x16x32_bf16 a[28:31], a[220:223], v[16:19], a[28:31]
v_exp_f32 v85, v85
v_mfma_f32_16x16x32_bf16 a[60:63], a[220:223], v[24:27], a[60:63]
v_add_f32 v248, v248, v84
v_add_f32 v248, v248, v85
v_mfma_f32_16x16x32_bf16 a[92:95], a[220:223], v[32:35], a[92:95]
v_exp_f32 v86, v86
v_mfma_f32_16x16x32_bf16 a[124:127], a[220:223], v[40:43], a[124:127]
v_cvt_pk_bf16_f32 v82, v84, v85
v_add_f32 v248, v248, v86
v_mfma_f32_16x16x32_bf16 a[156:159], a[220:223], v[48:51], a[156:159]
v_exp_f32 v87, v87
v_mfma_f32_16x16x32_bf16 a[188:191], a[220:223], v[56:59], a[188:191]
s_waitcnt lgkmcnt(0)
v_add_f32 v248, v248, v87
v_cvt_pk_bf16_f32 v83, v86, v87
v_mfma_f32_16x16x32_bf16 v[16:19], a[224:227], v[112:115], v[208:211]
v_exp_f32 v88, v88
v_mfma_f32_16x16x32_bf16 v[16:19], a[228:231], v[116:119], v[16:19]
v_add_f32 v249, v249, v88
v_mfma_f32_16x16x32_bf16 v[16:19], a[232:235], v[120:123], v[16:19]
s_waitcnt lgkmcnt(0) vmcnt(11)
s_barrier
v_exp_f32 v89, v89
v_mfma_f32_16x16x32_bf16 v[16:19], a[236:239], v[124:127], v[16:19]
ds_read_b64_tr_b16 a[192:193], v236 offset:8192
v_add_f32 v249, v249, v89
v_mfma_f32_16x16x32_bf16 v[20:23], a[240:243], v[112:115], v[208:211]
v_exp_f32 v90, v90
v_mfma_f32_16x16x32_bf16 v[20:23], a[244:247], v[116:119], v[20:23]
ds_read_b64_tr_b16 a[194:195], v236 offset:12288
v_cvt_pk_bf16_f32 v88, v88, v89
v_mfma_f32_16x16x32_bf16 v[20:23], a[248:251], v[120:123], v[20:23]
s_add_u32 m0, s22, 0x4000
v_exp_f32 v91, v91
v_mfma_f32_16x16x32_bf16 v[20:23], a[252:255], v[124:127], v[20:23]
buffer_load_dwordx4 v244, s[4:7], s20 offen nt lds
v_add_f32 v249, v249, v90
v_mfma_f32_16x16x32_bf16 v[24:27], a[224:227], v[128:131], v[212:215]
v_exp_f32 v92, v92
v_mfma_f32_16x16x32_bf16 v[24:27], a[228:231], v[132:135], v[24:27]
ds_read_b64_tr_b16 a[196:197], v237 offset:8192
v_add_f32 v249, v249, v91
v_mfma_f32_16x16x32_bf16 v[24:27], a[232:235], v[136:139], v[24:27]
v_exp_f32 v93, v93
v_mfma_f32_16x16x32_bf16 v[24:27], a[236:239], v[140:143], v[24:27]
v_cvt_pk_bf16_f32 v89, v90, v91
v_add_f32 v249, v249, v92
v_mfma_f32_16x16x32_bf16 v[28:31], a[240:243], v[128:131], v[212:215]
v_exp_f32 v94, v94
v_mfma_f32_16x16x32_bf16 v[28:31], a[244:247], v[132:135], v[28:31]
ds_read_b64_tr_b16 a[198:199], v237 offset:12288
v_add_f32 v249, v249, v93
v_mfma_f32_16x16x32_bf16 v[28:31], a[248:251], v[136:139], v[28:31]
v_exp_f32 v95, v95
v_mfma_f32_16x16x32_bf16 v[28:31], a[252:255], v[140:143], v[28:31]
buffer_load_dwordx4 v244, s[4:7], s20 offen offset:2048 nt lds
v_cvt_pk_bf16_f32 v90, v92, v93
v_mfma_f32_16x16x32_bf16 v[32:35], a[224:227], v[144:147], v[216:219]
s_add_u32 s20, s20, 0x2000
v_exp_f32 v96, v96
v_mfma_f32_16x16x32_bf16 v[32:35], a[228:231], v[148:151], v[32:35]
ds_read_b64_tr_b16 a[200:201], v238 offset:8192
v_add_f32 v249, v249, v94
v_mfma_f32_16x16x32_bf16 v[32:35], a[232:235], v[152:155], v[32:35]
v_exp_f32 v97, v97
v_mfma_f32_16x16x32_bf16 v[32:35], a[236:239], v[156:159], v[32:35]
v_add_f32 v249, v249, v95
v_cvt_pk_bf16_f32 v91, v94, v95
v_mfma_f32_16x16x32_bf16 v[36:39], a[240:243], v[144:147], v[216:219]
v_exp_f32 v98, v98
v_mfma_f32_16x16x32_bf16 v[36:39], a[244:247], v[148:151], v[36:39]
ds_read_b64_tr_b16 a[202:203], v238 offset:12288
v_add_f32 v250, v250, v96
v_mfma_f32_16x16x32_bf16 v[36:39], a[248:251], v[152:155], v[36:39]
s_add_u32 m0, s22, 0x8000
v_exp_f32 v99, v99
v_mfma_f32_16x16x32_bf16 v[36:39], a[252:255], v[156:159], v[36:39]
buffer_load_dwordx4 v244, s[8:11], s21 offen nt lds
v_add_f32 v250, v250, v97
v_mfma_f32_16x16x32_bf16 v[40:43], a[224:227], v[160:163], v[220:223]
v_exp_f32 v100, v100
v_mfma_f32_16x16x32_bf16 v[40:43], a[228:231], v[164:167], v[40:43]
ds_read_b64_tr_b16 a[204:205], v239 offset:8192
v_cvt_pk_bf16_f32 v96, v96, v97
v_mfma_f32_16x16x32_bf16 v[40:43], a[232:235], v[168:171], v[40:43]
v_exp_f32 v101, v101
v_mfma_f32_16x16x32_bf16 v[40:43], a[236:239], v[172:175], v[40:43]
v_add_f32 v250, v250, v98
v_add_f32 v250, v250, v99
v_mfma_f32_16x16x32_bf16 v[44:47], a[240:243], v[160:163], v[220:223]
v_exp_f32 v102, v102
v_mfma_f32_16x16x32_bf16 v[44:47], a[244:247], v[164:167], v[44:47]
ds_read_b64_tr_b16 a[206:207], v239 offset:12288
v_cvt_pk_bf16_f32 v97, v98, v99
v_mfma_f32_16x16x32_bf16 v[44:47], a[248:251], v[168:171], v[44:47]
v_exp_f32 v103, v103
v_mfma_f32_16x16x32_bf16 v[44:47], a[252:255], v[172:175], v[44:47]
buffer_load_dwordx4 v244, s[8:11], s21 offen offset:2048 nt lds
v_add_f32 v250, v250, v100
v_mfma_f32_16x16x32_bf16 v[48:51], a[224:227], v[176:179], v[224:227]
s_add_u32 s21, s21, 0x2000
v_exp_f32 v104, v104
v_mfma_f32_16x16x32_bf16 v[48:51], a[228:231], v[180:183], v[48:51]
ds_read_b64_tr_b16 a[208:209], v240 offset:8192
v_add_f32 v250, v250, v101
v_mfma_f32_16x16x32_bf16 v[48:51], a[232:235], v[184:187], v[48:51]
v_exp_f32 v105, v105
v_mfma_f32_16x16x32_bf16 v[48:51], a[236:239], v[188:191], v[48:51]
v_cvt_pk_bf16_f32 v98, v100, v101
v_add_f32 v250, v250, v102
v_mfma_f32_16x16x32_bf16 v[52:55], a[240:243], v[176:179], v[224:227]
v_exp_f32 v106, v106
v_mfma_f32_16x16x32_bf16 v[52:55], a[244:247], v[180:183], v[52:55]
ds_read_b64_tr_b16 a[210:211], v240 offset:12288
v_add_f32 v250, v250, v103
v_mfma_f32_16x16x32_bf16 v[52:55], a[248:251], v[184:187], v[52:55]
s_mov_b32 m0, s23
v_exp_f32 v107, v107
v_mfma_f32_16x16x32_bf16 v[52:55], a[252:255], v[188:191], v[52:55]
buffer_load_dwordx4 v244, s[12:15], s38 offen offset:2048 nt lds
v_cvt_pk_bf16_f32 v99, v102, v103
v_mfma_f32_16x16x32_bf16 v[56:59], a[224:227], v[192:195], v[228:231]
s_add_u32 s38, s38, 0x2000
v_exp_f32 v108, v108
v_mfma_f32_16x16x32_bf16 v[56:59], a[228:231], v[196:199], v[56:59]
ds_read_b64_tr_b16 a[212:213], v241 offset:8192
v_add_f32 v251, v251, v104
v_mfma_f32_16x16x32_bf16 v[56:59], a[232:235], v[200:203], v[56:59]
s_min_u32 s38, s38, s29
v_exp_f32 v109, v109
v_mfma_f32_16x16x32_bf16 v[56:59], a[236:239], v[204:207], v[56:59]
v_add_f32 v251, v251, v105
v_cvt_pk_bf16_f32 v104, v104, v105
v_mfma_f32_16x16x32_bf16 v[60:63], a[240:243], v[192:195], v[228:231]
s_add_u32 s23, s23, 0x2000
v_exp_f32 v110, v110
v_mfma_f32_16x16x32_bf16 v[60:63], a[244:247], v[196:199], v[60:63]
ds_read_b64_tr_b16 a[214:215], v241 offset:12288
v_add_f32 v251, v251, v106
v_mfma_f32_16x16x32_bf16 v[60:63], a[248:251], v[200:203], v[60:63]
s_min_u32 s23, s23, s41
v_exp_f32 v111, v111
v_mfma_f32_16x16x32_bf16 v[60:63], a[252:255], v[204:207], v[60:63]
s_waitcnt lgkmcnt(10)
v_add_f32 v251, v251, v107
v_cvt_pk_bf16_f32 v105, v106, v107
v_add_f32 v251, v251, v108
v_add_f32 v251, v251, v109
v_cvt_pk_bf16_f32 v106, v108, v109
v_add_f32 v251, v251, v110
v_add_f32 v251, v251, v111
v_cvt_pk_bf16_f32 v107, v110, v111
s_add_u32 s28, s28, 1
s_branch L_loopq
L_loopo_pre:
L_loopo:
v_mfma_f32_16x16x32_bf16 a[0:3], a[192:195], v[64:67], a[0:3]
v_exp_f32 v16, v16
v_mfma_f32_16x16x32_bf16 a[32:35], a[192:195], v[72:75], a[32:35]
ds_read_b64_tr_b16 a[216:217], v242 offset:8192
v_add_f32 v246, v246, v16
v_mfma_f32_16x16x32_bf16 a[64:67], a[192:195], v[80:83], a[64:67]
v_exp_f32 v17, v17
v_mfma_f32_16x16x32_bf16 a[96:99], a[192:195], v[88:91], a[96:99]
ds_read_b128 v[0:3], v4 offset:0
v_add_f32 v246, v246, v17
v_mfma_f32_16x16x32_bf16 a[128:131], a[192:195], v[96:99], a[128:131]
v_exp_f32 v18, v18
v_mfma_f32_16x16x32_bf16 a[160:163], a[192:195], v[104:107], a[160:163]
s_waitcnt lgkmcnt(10)
ds_read_b64_tr_b16 a[218:219], v242 offset:12288
v_cvt_pk_bf16_f32 v16, v16, v17
v_mfma_f32_16x16x32_bf16 a[4:7], a[196:199], v[64:67], a[4:7]
v_exp_f32 v19, v19
v_mfma_f32_16x16x32_bf16 a[36:39], a[196:199], v[72:75], a[36:39]
v_add_f32 v246, v246, v18
v_add_f32 v246, v246, v19
v_mfma_f32_16x16x32_bf16 a[68:71], a[196:199], v[80:83], a[68:71]
s_cmp_lt_u32 s28, 6
v_exp_f32 v20, v20
v_mfma_f32_16x16x32_bf16 a[100:103], a[196:199], v[88:91], a[100:103]
ds_read_b64_tr_b16 a[220:221], v243 offset:8192
v_cvt_pk_bf16_f32 v17, v18, v19
v_mfma_f32_16x16x32_bf16 a[132:135], a[196:199], v[96:99], a[132:135]
s_cselect_b32 s33, s32, s42
v_exp_f32 v21, v21
v_mfma_f32_16x16x32_bf16 a[164:167], a[196:199], v[104:107], a[164:167]
s_waitcnt lgkmcnt(10)
v_add_f32 v246, v246, v20
v_add_f32 v246, v246, v21
v_mfma_f32_16x16x32_bf16 a[8:11], a[200:203], v[64:67], a[8:11]
s_cmp_lt_u32 s28, 5
v_exp_f32 v22, v22
v_mfma_f32_16x16x32_bf16 a[40:43], a[200:203], v[72:75], a[40:43]
ds_read_b64_tr_b16 a[222:223], v243 offset:12288
v_cvt_pk_bf16_f32 v18, v20, v21
v_mfma_f32_16x16x32_bf16 a[72:75], a[200:203], v[80:83], a[72:75]
s_cselect_b32 s34, 0x1000, 0
v_exp_f32 v23, v23
v_mfma_f32_16x16x32_bf16 a[104:107], a[200:203], v[88:91], a[104:107]
v_add_f32 v246, v246, v22
v_add_f32 v246, v246, v23
v_mfma_f32_16x16x32_bf16 a[136:139], a[200:203], v[96:99], a[136:139]
v_exp_f32 v24, v24
v_mfma_f32_16x16x32_bf16 a[168:171], a[200:203], v[104:107], a[168:171]
s_waitcnt lgkmcnt(9)
ds_read_b128 a[224:227], v232 offset:24576
v_cvt_pk_bf16_f32 v19, v22, v23
v_mfma_f32_16x16x32_bf16 a[12:15], a[204:207], v[64:67], a[12:15]
v_exp_f32 v25, v25
v_mfma_f32_16x16x32_bf16 a[44:47], a[204:207], v[72:75], a[44:47]
ds_read_b128 a[228:231], v233 offset:24576
v_add_f32 v247, v247, v24
v_mfma_f32_16x16x32_bf16 a[76:79], a[204:207], v[80:83], a[76:79]
v_exp_f32 v26, v26
v_mfma_f32_16x16x32_bf16 a[108:111], a[204:207], v[88:91], a[108:111]
ds_read_b128 a[232:235], v234 offset:24576
v_add_f32 v247, v247, v25
v_mfma_f32_16x16x32_bf16 a[140:143], a[204:207], v[96:99], a[140:143]
s_waitcnt lgkmcnt(6)
v_exp_f32 v27, v27
v_mfma_f32_16x16x32_bf16 a[172:175], a[204:207], v[104:107], a[172:175]
s_waitcnt lgkmcnt(10)
buffer_store_dwordx4 v[0:3], v245, s[16:19], s33 offen sc1 nt
v_cvt_pk_bf16_f32 v24, v24, v25
v_mfma_f32_16x16x32_bf16 a[16:19], a[208:211], v[64:67], a[16:19]
s_add_u32 s32, s32, 0x400
v_exp_f32 v28, v28
v_mfma_f32_16x16x32_bf16 a[48:51], a[208:211], v[72:75], a[48:51]
ds_read_b128 a[236:239], v235 offset:24576
v_add_f32 v247, v247, v26
v_mfma_f32_16x16x32_bf16 a[80:83], a[208:211], v[80:83], a[80:83]
v_exp_f32 v29, v29
v_mfma_f32_16x16x32_bf16 a[112:115], a[208:211], v[88:91], a[112:115]
v_add_u32 v4, s34, v4
v_add_f32 v247, v247, v27
v_mfma_f32_16x16x32_bf16 a[144:147], a[208:211], v[96:99], a[144:147]
v_exp_f32 v30, v30
v_mfma_f32_16x16x32_bf16 a[176:179], a[208:211], v[104:107], a[176:179]
s_waitcnt lgkmcnt(9)
ds_read_b128 a[240:243], v232 offset:28672
v_cvt_pk_bf16_f32 v25, v26, v27
v_mfma_f32_16x16x32_bf16 a[20:23], a[212:215], v[64:67], a[20:23]
v_exp_f32 v31, v31
v_mfma_f32_16x16x32_bf16 a[52:55], a[212:215], v[72:75], a[52:55]
v_add_f32 v247, v247, v28
v_add_f32 v247, v247, v29
v_mfma_f32_16x16x32_bf16 a[84:87], a[212:215], v[80:83], a[84:87]
v_exp_f32 v32, v32
v_mfma_f32_16x16x32_bf16 a[116:119], a[212:215], v[88:91], a[116:119]
ds_read_b128 a[244:247], v233 offset:28672
v_cvt_pk_bf16_f32 v26, v28, v29
v_mfma_f32_16x16x32_bf16 a[148:151], a[212:215], v[96:99], a[148:151]
v_exp_f32 v33, v33
v_mfma_f32_16x16x32_bf16 a[180:183], a[212:215], v[104:107], a[180:183]
s_waitcnt lgkmcnt(8)
v_add_f32 v247, v247, v30
v_add_f32 v247, v247, v31
v_mfma_f32_16x16x32_bf16 a[24:27], a[216:219], v[64:67], a[24:27]
v_exp_f32 v34, v34
v_mfma_f32_16x16x32_bf16 a[56:59], a[216:219], v[72:75], a[56:59]
ds_read_b128 a[248:251], v234 offset:28672
v_cvt_pk_bf16_f32 v27, v30, v31
v_mfma_f32_16x16x32_bf16 a[88:91], a[216:219], v[80:83], a[88:91]
v_exp_f32 v35, v35
v_mfma_f32_16x16x32_bf16 a[120:123], a[216:219], v[88:91], a[120:123]
v_add_f32 v248, v248, v32
v_add_f32 v248, v248, v33
v_mfma_f32_16x16x32_bf16 a[152:155], a[216:219], v[96:99], a[152:155]
v_exp_f32 v36, v36
v_mfma_f32_16x16x32_bf16 a[184:187], a[216:219], v[104:107], a[184:187]
s_waitcnt lgkmcnt(7)
ds_read_b128 a[252:255], v235 offset:28672
v_cvt_pk_bf16_f32 v32, v32, v33
v_mfma_f32_16x16x32_bf16 a[28:31], a[220:223], v[64:67], a[28:31]
v_exp_f32 v37, v37
v_mfma_f32_16x16x32_bf16 a[60:63], a[220:223], v[72:75], a[60:63]
v_add_f32 v248, v248, v34
v_add_f32 v248, v248, v35
v_mfma_f32_16x16x32_bf16 a[92:95], a[220:223], v[80:83], a[92:95]
v_exp_f32 v38, v38
v_mfma_f32_16x16x32_bf16 a[124:127], a[220:223], v[88:91], a[124:127]
v_cvt_pk_bf16_f32 v33, v34, v35
v_add_f32 v248, v248, v36
v_mfma_f32_16x16x32_bf16 a[156:159], a[220:223], v[96:99], a[156:159]
v_exp_f32 v39, v39
v_mfma_f32_16x16x32_bf16 a[188:191], a[220:223], v[104:107], a[188:191]
s_waitcnt lgkmcnt(0)
v_add_f32 v248, v248, v37
v_cvt_pk_bf16_f32 v34, v36, v37
v_mfma_f32_16x16x32_bf16 v[64:67], a[224:227], v[112:115], v[208:211]
v_exp_f32 v40, v40
v_mfma_f32_16x16x32_bf16 v[64:67], a[228:231], v[116:119], v[64:67]
v_add_f32 v248, v248, v38
v_add_f32 v248, v248, v39
v_mfma_f32_16x16x32_bf16 v[64:67], a[232:235], v[120:123], v[64:67]
s_waitcnt lgkmcnt(0) vmcnt(11)
s_barrier
v_exp_f32 v41, v41
v_mfma_f32_16x16x32_bf16 v[64:67], a[236:239], v[124:127], v[64:67]
ds_read_b64_tr_b16 a[192:193], v236 offset:16384
v_cvt_pk_bf16_f32 v35, v38, v39
v_mfma_f32_16x16x32_bf16 v[68:71], a[240:243], v[112:115], v[208:211]
v_exp_f32 v42, v42
v_mfma_f32_16x16x32_bf16 v[68:71], a[244:247], v[116:119], v[68:71]
ds_read_b64_tr_b16 a[194:195], v236 offset:20480
v_add_f32 v249, v249, v40
v_mfma_f32_16x16x32_bf16 v[68:71], a[248:251], v[120:123], v[68:71]
s_add_u32 m0, s22, 0x6000
v_exp_f32 v43, v43
v_mfma_f32_16x16x32_bf16 v[68:71], a[252:255], v[124:127], v[68:71]
buffer_load_dwordx4 v244, s[4:7], s20 offen nt lds
v_add_f32 v249, v249, v41
v_mfma_f32_16x16x32_bf16 v[72:75], a[224:227], v[128:131], v[212:215]
v_exp_f32 v44, v44
v_mfma_f32_16x16x32_bf16 v[72:75], a[228:231], v[132:135], v[72:75]
ds_read_b64_tr_b16 a[196:197], v237 offset:16384
v_cvt_pk_bf16_f32 v40, v40, v41
v_mfma_f32_16x16x32_bf16 v[72:75], a[232:235], v[136:139], v[72:75]
v_exp_f32 v45, v45
v_mfma_f32_16x16x32_bf16 v[72:75], a[236:239], v[140:143], v[72:75]
v_add_f32 v249, v249, v42
v_add_f32 v249, v249, v43
v_mfma_f32_16x16x32_bf16 v[76:79], a[240:243], v[128:131], v[212:215]
v_exp_f32 v46, v46
v_mfma_f32_16x16x32_bf16 v[76:79], a[244:247], v[132:135], v[76:79]
ds_read_b64_tr_b16 a[198:199], v237 offset:20480
v_cvt_pk_bf16_f32 v41, v42, v43
v_mfma_f32_16x16x32_bf16 v[76:79], a[248:251], v[136:139], v[76:79]
v_exp_f32 v47, v47
v_mfma_f32_16x16x32_bf16 v[76:79], a[252:255], v[140:143], v[76:79]
buffer_load_dwordx4 v244, s[4:7], s20 offen offset:2048 nt lds
v_add_f32 v249, v249, v44
v_mfma_f32_16x16x32_bf16 v[80:83], a[224:227], v[144:147], v[216:219]
s_add_u32 s20, s20, 0x2000
v_exp_f32 v48, v48
v_mfma_f32_16x16x32_bf16 v[80:83], a[228:231], v[148:151], v[80:83]
ds_read_b64_tr_b16 a[200:201], v238 offset:16384
v_add_f32 v249, v249, v45
v_mfma_f32_16x16x32_bf16 v[80:83], a[232:235], v[152:155], v[80:83]
v_exp_f32 v49, v49
v_mfma_f32_16x16x32_bf16 v[80:83], a[236:239], v[156:159], v[80:83]
v_cvt_pk_bf16_f32 v42, v44, v45
v_add_f32 v249, v249, v46
v_mfma_f32_16x16x32_bf16 v[84:87], a[240:243], v[144:147], v[216:219]
v_exp_f32 v50, v50
v_mfma_f32_16x16x32_bf16 v[84:87], a[244:247], v[148:151], v[84:87]
ds_read_b64_tr_b16 a[202:203], v238 offset:20480
v_add_f32 v249, v249, v47
v_mfma_f32_16x16x32_bf16 v[84:87], a[248:251], v[152:155], v[84:87]
s_add_u32 m0, s22, 0xa000
v_exp_f32 v51, v51
v_mfma_f32_16x16x32_bf16 v[84:87], a[252:255], v[156:159], v[84:87]
buffer_load_dwordx4 v244, s[8:11], s21 offen nt lds
v_cvt_pk_bf16_f32 v43, v46, v47
v_mfma_f32_16x16x32_bf16 v[88:91], a[224:227], v[160:163], v[220:223]
v_exp_f32 v52, v52
v_mfma_f32_16x16x32_bf16 v[88:91], a[228:231], v[164:167], v[88:91]
ds_read_b64_tr_b16 a[204:205], v239 offset:16384
v_add_f32 v250, v250, v48
v_mfma_f32_16x16x32_bf16 v[88:91], a[232:235], v[168:171], v[88:91]
v_exp_f32 v53, v53
v_mfma_f32_16x16x32_bf16 v[88:91], a[236:239], v[172:175], v[88:91]
v_add_f32 v250, v250, v49
v_cvt_pk_bf16_f32 v48, v48, v49
v_mfma_f32_16x16x32_bf16 v[92:95], a[240:243], v[160:163], v[220:223]
v_exp_f32 v54, v54
v_mfma_f32_16x16x32_bf16 v[92:95], a[244:247], v[164:167], v[92:95]
ds_read_b64_tr_b16 a[206:207], v239 offset:20480
v_add_f32 v250, v250, v50
v_mfma_f32_16x16x32_bf16 v[92:95], a[248:251], v[168:171], v[92:95]
v_exp_f32 v55, v55
v_mfma_f32_16x16x32_bf16 v[92:95], a[252:255], v[172:175], v[92:95]
buffer_load_dwordx4 v244, s[8:11], s21 offen offset:2048 nt lds
v_add_f32 v250, v250, v51
v_mfma_f32_16x16x32_bf16 v[96:99], a[224:227], v[176:179], v[224:227]
s_add_u32 s21, s21, 0x2000
v_exp_f32 v56, v56
v_mfma_f32_16x16x32_bf16 v[96:99], a[228:231], v[180:183], v[96:99]
ds_read_b64_tr_b16 a[208:209], v240 offset:16384
v_cvt_pk_bf16_f32 v49, v50, v51
v_mfma_f32_16x16x32_bf16 v[96:99], a[232:235], v[184:187], v[96:99]
v_exp_f32 v57, v57
v_mfma_f32_16x16x32_bf16 v[96:99], a[236:239], v[188:191], v[96:99]
v_add_f32 v250, v250, v52
v_add_f32 v250, v250, v53
v_mfma_f32_16x16x32_bf16 v[100:103], a[240:243], v[176:179], v[224:227]
v_exp_f32 v58, v58
v_mfma_f32_16x16x32_bf16 v[100:103], a[244:247], v[180:183], v[100:103]
ds_read_b64_tr_b16 a[210:211], v240 offset:20480
v_cvt_pk_bf16_f32 v50, v52, v53
v_mfma_f32_16x16x32_bf16 v[100:103], a[248:251], v[184:187], v[100:103]
v_exp_f32 v59, v59
v_mfma_f32_16x16x32_bf16 v[100:103], a[252:255], v[188:191], v[100:103]
v_add_f32 v250, v250, v54
v_add_f32 v250, v250, v55
v_mfma_f32_16x16x32_bf16 v[104:107], a[224:227], v[192:195], v[228:231]
v_exp_f32 v60, v60
v_mfma_f32_16x16x32_bf16 v[104:107], a[228:231], v[196:199], v[104:107]
ds_read_b64_tr_b16 a[212:213], v241 offset:16384
v_cvt_pk_bf16_f32 v51, v54, v55
v_mfma_f32_16x16x32_bf16 v[104:107], a[232:235], v[200:203], v[104:107]
v_exp_f32 v61, v61
v_mfma_f32_16x16x32_bf16 v[104:107], a[236:239], v[204:207], v[104:107]
v_add_f32 v251, v251, v56
v_add_f32 v251, v251, v57
v_mfma_f32_16x16x32_bf16 v[108:111], a[240:243], v[192:195], v[228:231]
v_exp_f32 v62, v62
v_mfma_f32_16x16x32_bf16 v[108:111], a[244:247], v[196:199], v[108:111]
ds_read_b64_tr_b16 a[214:215], v241 offset:20480
v_cvt_pk_bf16_f32 v56, v56, v57
v_mfma_f32_16x16x32_bf16 v[108:111], a[248:251], v[200:203], v[108:111]
v_exp_f32 v63, v63
v_mfma_f32_16x16x32_bf16 v[108:111], a[252:255], v[204:207], v[108:111]
s_waitcnt lgkmcnt(10)
v_add_f32 v251, v251, v58
v_add_f32 v251, v251, v59
v_cvt_pk_bf16_f32 v57, v58, v59
v_add_f32 v251, v251, v60
v_add_f32 v251, v251, v61
v_cvt_pk_bf16_f32 v58, v60, v61
v_add_f32 v251, v251, v62
v_add_f32 v251, v251, v63
v_cvt_pk_bf16_f32 v59, v62, v63
s_cmp_eq_u32 s28, 7
s_cbranch_scc1 L_tail
v_mfma_f32_16x16x32_bf16 a[0:3], a[192:195], v[16:19], a[0:3]
v_exp_f32 v64, v64
v_mfma_f32_16x16x32_bf16 a[32:35], a[192:195], v[24:27], a[32:35]
ds_read_b64_tr_b16 a[216:217], v242 offset:16384
v_add_f32 v246, v246, v64
v_mfma_f32_16x16x32_bf16 a[64:67], a[192:195], v[32:35], a[64:67]
v_exp_f32 v65, v65
v_mfma_f32_16x16x32_bf16 a[96:99], a[192:195], v[40:43], a[96:99]
ds_read_b128 v[0:3], v5 offset:1024
v_add_f32 v246, v246, v65
v_mfma_f32_16x16x32_bf16 a[128:131], a[192:195], v[48:51], a[128:131]
v_exp_f32 v66, v66
v_mfma_f32_16x16x32_bf16 a[160:163], a[192:195], v[56:59], a[160:163]
s_waitcnt lgkmcnt(10)
ds_read_b64_tr_b16 a[218:219], v242 offset:20480
v_cvt_pk_bf16_f32 v64, v64, v65
v_mfma_f32_16x16x32_bf16 a[4:7], a[196:199], v[16:19], a[4:7]
v_exp_f32 v67, v67
v_mfma_f32_16x16x32_bf16 a[36:39], a[196:199], v[24:27], a[36:39]
v_add_f32 v246, v246, v66
v_add_f32 v246, v246, v67
v_mfma_f32_16x16x32_bf16 a[68:71], a[196:199], v[32:35], a[68:71]
s_cmp_lt_u32 s28, 6
v_exp_f32 v68, v68
v_mfma_f32_16x16x32_bf16 a[100:103], a[196:199], v[40:43], a[100:103]
ds_read_b64_tr_b16 a[220:221], v243 offset:16384
v_cvt_pk_bf16_f32 v65, v66, v67
v_mfma_f32_16x16x32_bf16 a[132:135], a[196:199], v[48:51], a[132:135]
s_cselect_b32 s33, s32, s42
v_exp_f32 v69, v69
v_mfma_f32_16x16x32_bf16 a[164:167], a[196:199], v[56:59], a[164:167]
s_waitcnt lgkmcnt(10)
v_add_f32 v246, v246, v68
v_add_f32 v246, v246, v69
v_mfma_f32_16x16x32_bf16 a[8:11], a[200:203], v[16:19], a[8:11]
s_cmp_lt_u32 s28, 5
v_exp_f32 v70, v70
v_mfma_f32_16x16x32_bf16 a[40:43], a[200:203], v[24:27], a[40:43]
ds_read_b64_tr_b16 a[222:223], v243 offset:20480
v_cvt_pk_bf16_f32 v66, v68, v69
v_mfma_f32_16x16x32_bf16 a[72:75], a[200:203], v[32:35], a[72:75]
s_cselect_b32 s34, 0x1000, 0
v_exp_f32 v71, v71
v_mfma_f32_16x16x32_bf16 a[104:107], a[200:203], v[40:43], a[104:107]
v_add_f32 v246, v246, v70
v_add_f32 v246, v246, v71
v_mfma_f32_16x16x32_bf16 a[136:139], a[200:203], v[48:51], a[136:139]
v_exp_f32 v72, v72
v_mfma_f32_16x16x32_bf16 a[168:171], a[200:203], v[56:59], a[168:171]
s_waitcnt lgkmcnt(9)
ds_read_b128 a[224:227], v232 offset:0
v_cvt_pk_bf16_f32 v67, v70, v71
v_mfma_f32_16x16x32_bf16 a[12:15], a[204:207], v[16:19], a[12:15]
v_exp_f32 v73, v73
v_mfma_f32_16x16x32_bf16 a[44:47], a[204:207], v[24:27], a[44:47]
ds_read_b128 a[228:231], v233 offset:0
v_add_f32 v247, v247, v72
v_mfma_f32_16x16x32_bf16 a[76:79], a[204:207], v[32:35], a[76:79]
v_exp_f32 v74, v74
v_mfma_f32_16x16x32_bf16 a[108:111], a[204:207], v[40:43], a[108:111]
ds_read_b128 a[232:235], v234 offset:0
v_add_f32 v247, v247, v73
v_mfma_f32_16x16x32_bf16 a[140:143], a[204:207], v[48:51], a[140:143]
s_waitcnt lgkmcnt(6)
v_exp_f32 v75, v75
v_mfma_f32_16x16x32_bf16 a[172:175], a[204:207], v[56:59], a[172:175]
s_waitcnt lgkmcnt(10)
buffer_store_dwordx4 v[0:3], v245, s[16:19], s33 offen sc1 nt
v_cvt_pk_bf16_f32 v72, v72, v73
v_mfma_f32_16x16x32_bf16 a[16:19], a[208:211], v[16:19], a[16:19]
s_add_u32 s32, s32, 0x400
v_exp_f32 v76, v76
v_mfma_f32_16x16x32_bf16 a[48:51], a[208:211], v[24:27], a[48:51]
ds_read_b128 a[236:239], v235 offset:0
v_add_f32 v247, v247, v74
v_mfma_f32_16x16x32_bf16 a[80:83], a[208:211], v[32:35], a[80:83]
v_exp_f32 v77, v77
v_mfma_f32_16x16x32_bf16 a[112:115], a[208:211], v[40:43], a[112:115]
v_add_u32 v5, s34, v5
v_add_f32 v247, v247, v75
v_mfma_f32_16x16x32_bf16 a[144:147], a[208:211], v[48:51], a[144:147]
v_exp_f32 v78, v78
v_mfma_f32_16x16x32_bf16 a[176:179], a[208:211], v[56:59], a[176:179]
s_waitcnt lgkmcnt(9)
ds_read_b128 a[240:243], v232 offset:4096
v_cvt_pk_bf16_f32 v73, v74, v75
v_mfma_f32_16x16x32_bf16 a[20:23], a[212:215], v[16:19], a[20:23]
v_exp_f32 v79, v79
v_mfma_f32_16x16x32_bf16 a[52:55], a[212:215], v[24:27], a[52:55]
v_add_f32 v247, v247, v76
v_add_f32 v247, v247, v77
v_mfma_f32_16x16x32_bf16 a[84:87], a[212:215], v[32:35], a[84:87]
v_exp_f32 v80, v80
v_mfma_f32_16x16x32_bf16 a[116:119], a[212:215], v[40:43], a[116:119]
ds_read_b128 a[244:247], v233 offset:4096
v_cvt_pk_bf16_f32 v74, v76, v77
v_mfma_f32_16x16x32_bf16 a[148:151], a[212:215], v[48:51], a[148:151]
v_exp_f32 v81, v81
v_mfma_f32_16x16x32_bf16 a[180:183], a[212:215], v[56:59], a[180:183]
s_waitcnt lgkmcnt(8)
v_add_f32 v247, v247, v78
v_add_f32 v247, v247, v79
v_mfma_f32_16x16x32_bf16 a[24:27], a[216:219], v[16:19], a[24:27]
v_exp_f32 v82, v82
v_mfma_f32_16x16x32_bf16 a[56:59], a[216:219], v[24:27], a[56:59]
ds_read_b128 a[248:251], v234 offset:4096
v_cvt_pk_bf16_f32 v75, v78, v79
v_mfma_f32_16x16x32_bf16 a[88:91], a[216:219], v[32:35], a[88:91]
v_exp_f32 v83, v83
v_mfma_f32_16x16x32_bf16 a[120:123], a[216:219], v[40:43], a[120:123]
v_add_f32 v248, v248, v80
v_add_f32 v248, v248, v81
v_mfma_f32_16x16x32_bf16 a[152:155], a[216:219], v[48:51], a[152:155]
v_exp_f32 v84, v84
v_mfma_f32_16x16x32_bf16 a[184:187], a[216:219], v[56:59], a[184:187]
s_waitcnt lgkmcnt(7)
ds_read_b128 a[252:255], v235 offset:4096
v_cvt_pk_bf16_f32 v80, v80, v81
v_mfma_f32_16x16x32_bf16 a[28:31], a[220:223], v[16:19], a[28:31]
v_exp_f32 v85, v85
v_mfma_f32_16x16x32_bf16 a[60:63], a[220:223], v[24:27], a[60:63]
v_add_f32 v248, v248, v82
v_add_f32 v248, v248, v83
v_mfma_f32_16x16x32_bf16 a[92:95], a[220:223], v[32:35], a[92:95]
v_exp_f32 v86, v86
v_mfma_f32_16x16x32_bf16 a[124:127], a[220:223], v[40:43], a[124:127]
v_cvt_pk_bf16_f32 v81, v82, v83
v_add_f32 v248, v248, v84
v_mfma_f32_16x16x32_bf16 a[156:159], a[220:223], v[48:51], a[156:159]
v_exp_f32 v87, v87
v_mfma_f32_16x16x32_bf16 a[188:191], a[220:223], v[56:59], a[188:191]
s_waitcnt lgkmcnt(0)
v_add_f32 v248, v248, v85
v_cvt_pk_bf16_f32 v82, v84, v85
v_mfma_f32_16x16x32_bf16 v[16:19], a[224:227], v[112:115], v[208:211]
v_exp_f32 v88, v88
v_mfma_f32_16x16x32_bf16 v[16:19], a[228:231], v[116:119], v[16:19]
v_add_f32 v248, v248, v86
v_add_f32 v248, v248, v87
v_mfma_f32_16x16x32_bf16 v[16:19], a[232:235], v[120:123], v[16:19]
s_waitcnt lgkmcnt(0) vmcnt(11)
s_barrier
v_exp_f32 v89, v89
v_mfma_f32_16x16x32_bf16 v[16:19], a[236:239], v[124:127], v[16:19]
ds_read_b64_tr_b16 a[192:193], v236 offset:24576
v_cvt_pk_bf16_f32 v83, v86, v87
v_mfma_f32_16x16x32_bf16 v[20:23], a[240:243], v[112:115], v[208:211]
v_exp_f32 v90, v90
v_mfma_f32_16x16x32_bf16 v[20:23], a[244:247], v[116:119], v[20:23]
ds_read_b64_tr_b16 a[194:195], v236 offset:28672
v_add_f32 v249, v249, v88
v_mfma_f32_16x16x32_bf16 v[20:23], a[248:251], v[120:123], v[20:23]
s_add_u32 m0, s22, 0x0
v_exp_f32 v91, v91
v_mfma_f32_16x16x32_bf16 v[20:23], a[252:255], v[124:127], v[20:23]
buffer_load_dwordx4 v244, s[4:7], s20 offen nt lds
v_add_f32 v249, v249, v89
v_mfma_f32_16x16x32_bf16 v[24:27], a[224:227], v[128:131], v[212:215]
v_exp_f32 v92, v92
v_mfma_f32_16x16x32_bf16 v[24:27], a[228:231], v[132:135], v[24:27]
ds_read_b64_tr_b16 a[196:197], v237 offset:24576
v_cvt_pk_bf16_f32 v88, v88, v89
v_mfma_f32_16x16x32_bf16 v[24:27], a[232:235], v[136:139], v[24:27]
v_exp_f32 v93, v93
v_mfma_f32_16x16x32_bf16 v[24:27], a[236:239], v[140:143], v[24:27]
v_add_f32 v249, v249, v90
v_add_f32 v249, v249, v91
v_mfma_f32_16x16x32_bf16 v[28:31], a[240:243], v[128:131], v[212:215]
v_exp_f32 v94, v94
v_mfma_f32_16x16x32_bf16 v[28:31], a[244:247], v[132:135], v[28:31]
ds_read_b64_tr_b16 a[198:199], v237 offset:28672
v_cvt_pk_bf16_f32 v89, v90, v91
v_mfma_f32_16x16x32_bf16 v[28:31], a[248:251], v[136:139], v[28:31]
v_exp_f32 v95, v95
v_mfma_f32_16x16x32_bf16 v[28:31], a[252:255], v[140:143], v[28:31]
buffer_load_dwordx4 v244, s[4:7], s20 offen offset:2048 nt lds
v_add_f32 v249, v249, v92
v_mfma_f32_16x16x32_bf16 v[32:35], a[224:227], v[144:147], v[216:219]
s_add_u32 s20, s20, 0x2000
v_exp_f32 v96, v96
v_mfma_f32_16x16x32_bf16 v[32:35], a[228:231], v[148:151], v[32:35]
ds_read_b64_tr_b16 a[200:201], v238 offset:24576
v_add_f32 v249, v249, v93
v_mfma_f32_16x16x32_bf16 v[32:35], a[232:235], v[152:155], v[32:35]
v_exp_f32 v97, v97
v_mfma_f32_16x16x32_bf16 v[32:35], a[236:239], v[156:159], v[32:35]
v_cvt_pk_bf16_f32 v90, v92, v93
v_add_f32 v249, v249, v94
v_mfma_f32_16x16x32_bf16 v[36:39], a[240:243], v[144:147], v[216:219]
v_exp_f32 v98, v98
v_mfma_f32_16x16x32_bf16 v[36:39], a[244:247], v[148:151], v[36:39]
ds_read_b64_tr_b16 a[202:203], v238 offset:28672
v_add_f32 v249, v249, v95
v_mfma_f32_16x16x32_bf16 v[36:39], a[248:251], v[152:155], v[36:39]
s_add_u32 m0, s22, 0xc000
v_exp_f32 v99, v99
v_mfma_f32_16x16x32_bf16 v[36:39], a[252:255], v[156:159], v[36:39]
buffer_load_dwordx4 v244, s[8:11], s21 offen nt lds
v_cvt_pk_bf16_f32 v91, v94, v95
v_mfma_f32_16x16x32_bf16 v[40:43], a[224:227], v[160:163], v[220:223]
v_exp_f32 v100, v100
v_mfma_f32_16x16x32_bf16 v[40:43], a[228:231], v[164:167], v[40:43]
ds_read_b64_tr_b16 a[204:205], v239 offset:24576
v_add_f32 v250, v250, v96
v_mfma_f32_16x16x32_bf16 v[40:43], a[232:235], v[168:171], v[40:43]
v_exp_f32 v101, v101
v_mfma_f32_16x16x32_bf16 v[40:43], a[236:239], v[172:175], v[40:43]
v_add_f32 v250, v250, v97
v_cvt_pk_bf16_f32 v96, v96, v97
v_mfma_f32_16x16x32_bf16 v[44:47], a[240:243], v[160:163], v[220:223]
v_exp_f32 v102, v102
v_mfma_f32_16x16x32_bf16 v[44:47], a[244:247], v[164:167], v[44:47]
ds_read_b64_tr_b16 a[206:207], v239 offset:28672
v_add_f32 v250, v250, v98
v_mfma_f32_16x16x32_bf16 v[44:47], a[248:251], v[168:171], v[44:47]
v_exp_f32 v103, v103
v_mfma_f32_16x16x32_bf16 v[44:47], a[252:255], v[172:175], v[44:47]
buffer_load_dwordx4 v244, s[8:11], s21 offen offset:2048 nt lds
v_add_f32 v250, v250, v99
v_mfma_f32_16x16x32_bf16 v[48:51], a[224:227], v[176:179], v[224:227]
s_add_u32 s21, s21, 0x2000
v_exp_f32 v104, v104
v_mfma_f32_16x16x32_bf16 v[48:51], a[228:231], v[180:183], v[48:51]
ds_read_b64_tr_b16 a[208:209], v240 offset:24576
v_cvt_pk_bf16_f32 v97, v98, v99
v_mfma_f32_16x16x32_bf16 v[48:51], a[232:235], v[184:187], v[48:51]
v_exp_f32 v105, v105
v_mfma_f32_16x16x32_bf16 v[48:51], a[236:239], v[188:191], v[48:51]
v_add_f32 v250, v250, v100
v_add_f32 v250, v250, v101
v_mfma_f32_16x16x32_bf16 v[52:55], a[240:243], v[176:179], v[224:227]
v_exp_f32 v106, v106
v_mfma_f32_16x16x32_bf16 v[52:55], a[244:247], v[180:183], v[52:55]
ds_read_b64_tr_b16 a[210:211], v240 offset:28672
v_cvt_pk_bf16_f32 v98, v100, v101
v_mfma_f32_16x16x32_bf16 v[52:55], a[248:251], v[184:187], v[52:55]
v_exp_f32 v107, v107
v_mfma_f32_16x16x32_bf16 v[52:55], a[252:255], v[188:191], v[52:55]
v_add_f32 v250, v250, v102
v_add_f32 v250, v250, v103
v_mfma_f32_16x16x32_bf16 v[56:59], a[224:227], v[192:195], v[228:231]
v_exp_f32 v108, v108
v_mfma_f32_16x16x32_bf16 v[56:59], a[228:231], v[196:199], v[56:59]
ds_read_b64_tr_b16 a[212:213], v241 offset:24576
v_cvt_pk_bf16_f32 v99, v102, v103
v_mfma_f32_16x16x32_bf16 v[56:59], a[232:235], v[200:203], v[56:59]
v_exp_f32 v109, v109
v_mfma_f32_16x16x32_bf16 v[56:59], a[236:239], v[204:207], v[56:59]
v_add_f32 v251, v251, v104
v_add_f32 v251, v251, v105
v_mfma_f32_16x16x32_bf16 v[60:63], a[240:243], v[192:195], v[228:231]
v_exp_f32 v110, v110
v_mfma_f32_16x16x32_bf16 v[60:63], a[244:247], v[196:199], v[60:63]
ds_read_b64_tr_b16 a[214:215], v241 offset:28672
v_cvt_pk_bf16_f32 v104, v104, v105
v_mfma_f32_16x16x32_bf16 v[60:63], a[248:251], v[200:203], v[60:63]
v_exp_f32 v111, v111
v_mfma_f32_16x16x32_bf16 v[60:63], a[252:255], v[204:207], v[60:63]
s_waitcnt lgkmcnt(10)
v_add_f32 v251, v251, v106
v_add_f32 v251, v251, v107
v_cvt_pk_bf16_f32 v105, v106, v107
v_add_f32 v251, v251, v108
v_add_f32 v251, v251, v109
v_cvt_pk_bf16_f32 v106, v108, v109
v_add_f32 v251, v251, v110
v_add_f32 v251, v251, v111
v_cvt_pk_bf16_f32 v107, v110, v111
v_mfma_f32_16x16x32_bf16 a[0:3], a[192:195], v[64:67], a[0:3]
v_exp_f32 v16, v16
v_mfma_f32_16x16x32_bf16 a[32:35], a[192:195], v[72:75], a[32:35]
ds_read_b64_tr_b16 a[216:217], v242 offset:24576
v_add_f32 v246, v246, v16
v_mfma_f32_16x16x32_bf16 a[64:67], a[192:195], v[80:83], a[64:67]
v_exp_f32 v17, v17
v_mfma_f32_16x16x32_bf16 a[96:99], a[192:195], v[88:91], a[96:99]
ds_read_b128 v[0:3], v6 offset:2048
v_add_f32 v246, v246, v17
v_mfma_f32_16x16x32_bf16 a[128:131], a[192:195], v[96:99], a[128:131]
v_exp_f32 v18, v18
v_mfma_f32_16x16x32_bf16 a[160:163], a[192:195], v[104:107], a[160:163]
s_waitcnt lgkmcnt(10)
ds_read_b64_tr_b16 a[218:219], v242 offset:28672
v_cvt_pk_bf16_f32 v16, v16, v17
v_mfma_f32_16x16x32_bf16 a[4:7], a[196:199], v[64:67], a[4:7]
v_exp_f32 v19, v19
v_mfma_f32_16x16x32_bf16 a[36:39], a[196:199], v[72:75], a[36:39]
v_add_f32 v246, v246, v18
v_add_f32 v246, v246, v19
v_mfma_f32_16x16x32_bf16 a[68:71], a[196:199], v[80:83], a[68:71]
s_cmp_lt_u32 s28, 6
v_exp_f32 v20, v20
v_mfma_f32_16x16x32_bf16 a[100:103], a[196:199], v[88:91], a[100:103]
ds_read_b64_tr_b16 a[220:221], v243 offset:24576
v_cvt_pk_bf16_f32 v17, v18, v19
v_mfma_f32_16x16x32_bf16 a[132:135], a[196:199], v[96:99], a[132:135]
s_cselect_b32 s33, s32, s42
v_exp_f32 v21, v21
v_mfma_f32_16x16x32_bf16 a[164:167], a[196:199], v[104:107], a[164:167]
s_waitcnt lgkmcnt(10)
v_add_f32 v246, v246, v20
v_add_f32 v246, v246, v21
v_mfma_f32_16x16x32_bf16 a[8:11], a[200:203], v[64:67], a[8:11]
s_cmp_lt_u32 s28, 5
v_exp_f32 v22, v22
v_mfma_f32_16x16x32_bf16 a[40:43], a[200:203], v[72:75], a[40:43]
ds_read_b64_tr_b16 a[222:223], v243 offset:28672
v_cvt_pk_bf16_f32 v18, v20, v21
v_mfma_f32_16x16x32_bf16 a[72:75], a[200:203], v[80:83], a[72:75]
s_cselect_b32 s34, 0x1000, 0
v_exp_f32 v23, v23
v_mfma_f32_16x16x32_bf16 a[104:107], a[200:203], v[88:91], a[104:107]
v_add_f32 v246, v246, v22
v_add_f32 v246, v246, v23
v_mfma_f32_16x16x32_bf16 a[136:139], a[200:203], v[96:99], a[136:139]
v_exp_f32 v24, v24
v_mfma_f32_16x16x32_bf16 a[168:171], a[200:203], v[104:107], a[168:171]
s_waitcnt lgkmcnt(9)
ds_read_b128 a[224:227], v232 offset:8192
v_cvt_pk_bf16_f32 v19, v22, v23
v_mfma_f32_16x16x32_bf16 a[12:15], a[204:207], v[64:67], a[12:15]
v_exp_f32 v25, v25
v_mfma_f32_16x16x32_bf16 a[44:47], a[204:207], v[72:75], a[44:47]
ds_read_b128 a[228:231], v233 offset:8192
v_add_f32 v247, v247, v24
v_mfma_f32_16x16x32_bf16 a[76:79], a[204:207], v[80:83], a[76:79]
v_exp_f32 v26, v26
v_mfma_f32_16x16x32_bf16 a[108:111], a[204:207], v[88:91], a[108:111]
ds_read_b128 a[232:235], v234 offset:8192
v_add_f32 v247, v247, v25
v_mfma_f32_16x16x32_bf16 a[140:143], a[204:207], v[96:99], a[140:143]
s_waitcnt lgkmcnt(6)
v_exp_f32 v27, v27
v_mfma_f32_16x16x32_bf16 a[172:175], a[204:207], v[104:107], a[172:175]
s_waitcnt lgkmcnt(10)
buffer_store_dwordx4 v[0:3], v245, s[16:19], s33 offen sc1 nt
v_cvt_pk_bf16_f32 v24, v24, v25
v_mfma_f32_16x16x32_bf16 a[16:19], a[208:211], v[64:67], a[16:19]
s_add_u32 s32, s32, 0x400
v_exp_f32 v28, v28
v_mfma_f32_16x16x32_bf16 a[48:51], a[208:211], v[72:75], a[48:51]
ds_read_b128 a[236:239], v235 offset:8192
v_add_f32 v247, v247, v26
v_mfma_f32_16x16x32_bf16 a[80:83], a[208:211], v[80:83], a[80:83]
v_exp_f32 v29, v29
v_mfma_f32_16x16x32_bf16 a[112:115], a[208:211], v[88:91], a[112:115]
v_add_u32 v6, s34, v6
v_add_f32 v247, v247, v27
v_mfma_f32_16x16x32_bf16 a[144:147], a[208:211], v[96:99], a[144:147]
v_exp_f32 v30, v30
v_mfma_f32_16x16x32_bf16 a[176:179], a[208:211], v[104:107], a[176:179]
s_waitcnt lgkmcnt(9)
ds_read_b128 a[240:243], v232 offset:12288
v_cvt_pk_bf16_f32 v25, v26, v27
v_mfma_f32_16x16x32_bf16 a[20:23], a[212:215], v[64:67], a[20:23]
v_exp_f32 v31, v31
v_mfma_f32_16x16x32_bf16 a[52:55], a[212:215], v[72:75], a[52:55]
v_add_f32 v247, v247, v28
v_add_f32 v247, v247, v29
v_mfma_f32_16x16x32_bf16 a[84:87], a[212:215], v[80:83], a[84:87]
v_exp_f32 v32, v32
v_mfma_f32_16x16x32_bf16 a[116:119], a[212:215], v[88:91], a[116:119]
ds_read_b128 a[244:247], v233 offset:12288
v_cvt_pk_bf16_f32 v26, v28, v29
v_mfma_f32_16x16x32_bf16 a[148:151], a[212:215], v[96:99], a[148:151]
v_exp_f32 v33, v33
v_mfma_f32_16x16x32_bf16 a[180:183], a[212:215], v[104:107], a[180:183]
s_waitcnt lgkmcnt(8)
v_add_f32 v247, v247, v30
v_add_f32 v247, v247, v31
v_mfma_f32_16x16x32_bf16 a[24:27], a[216:219], v[64:67], a[24:27]
v_exp_f32 v34, v34
v_mfma_f32_16x16x32_bf16 a[56:59], a[216:219], v[72:75], a[56:59]
ds_read_b128 a[248:251], v234 offset:12288
v_cvt_pk_bf16_f32 v27, v30, v31
v_mfma_f32_16x16x32_bf16 a[88:91], a[216:219], v[80:83], a[88:91]
v_exp_f32 v35, v35
v_mfma_f32_16x16x32_bf16 a[120:123], a[216:219], v[88:91], a[120:123]
v_add_f32 v248, v248, v32
v_add_f32 v248, v248, v33
v_mfma_f32_16x16x32_bf16 a[152:155], a[216:219], v[96:99], a[152:155]
v_exp_f32 v36, v36
v_mfma_f32_16x16x32_bf16 a[184:187], a[216:219], v[104:107], a[184:187]
s_waitcnt lgkmcnt(7)
ds_read_b128 a[252:255], v235 offset:12288
v_cvt_pk_bf16_f32 v32, v32, v33
v_mfma_f32_16x16x32_bf16 a[28:31], a[220:223], v[64:67], a[28:31]
v_exp_f32 v37, v37
v_mfma_f32_16x16x32_bf16 a[60:63], a[220:223], v[72:75], a[60:63]
v_add_f32 v248, v248, v34
v_add_f32 v248, v248, v35
v_mfma_f32_16x16x32_bf16 a[92:95], a[220:223], v[80:83], a[92:95]
v_exp_f32 v38, v38
v_mfma_f32_16x16x32_bf16 a[124:127], a[220:223], v[88:91], a[124:127]
v_cvt_pk_bf16_f32 v33, v34, v35
v_add_f32 v248, v248, v36
v_mfma_f32_16x16x32_bf16 a[156:159], a[220:223], v[96:99], a[156:159]
v_exp_f32 v39, v39
v_mfma_f32_16x16x32_bf16 a[188:191], a[220:223], v[104:107], a[188:191]
s_waitcnt lgkmcnt(0)
v_add_f32 v248, v248, v37
v_cvt_pk_bf16_f32 v34, v36, v37
v_mfma_f32_16x16x32_bf16 v[64:67], a[224:227], v[112:115], v[208:211]
v_exp_f32 v40, v40
v_mfma_f32_16x16x32_bf16 v[64:67], a[228:231], v[116:119], v[64:67]
v_add_f32 v248, v248, v38
v_add_f32 v248, v248, v39
v_mfma_f32_16x16x32_bf16 v[64:67], a[232:235], v[120:123], v[64:67]
s_waitcnt lgkmcnt(0) vmcnt(11)
s_barrier
v_exp_f32 v41, v41
v_mfma_f32_16x16x32_bf16 v[64:67], a[236:239], v[124:127], v[64:67]
ds_read_b64_tr_b16 a[192:193], v236 offset:0
v_cvt_pk_bf16_f32 v35, v38, v39
v_mfma_f32_16x16x32_bf16 v[68:71], a[240:243], v[112:115], v[208:211]
v_exp_f32 v42, v42
v_mfma_f32_16x16x32_bf16 v[68:71], a[244:247], v[116:119], v[68:71]
ds_read_b64_tr_b16 a[194:195], v236 offset:4096
v_add_f32 v249, v249, v40
v_mfma_f32_16x16x32_bf16 v[68:71], a[248:251], v[120:123], v[68:71]
s_add_u32 m0, s22, 0x2000
v_exp_f32 v43, v43
v_mfma_f32_16x16x32_bf16 v[68:71], a[252:255], v[124:127], v[68:71]
buffer_load_dwordx4 v244, s[4:7], s20 offen nt lds
v_add_f32 v249, v249, v41
v_mfma_f32_16x16x32_bf16 v[72:75], a[224:227], v[128:131], v[212:215]
v_exp_f32 v44, v44
v_mfma_f32_16x16x32_bf16 v[72:75], a[228:231], v[132:135], v[72:75]
ds_read_b64_tr_b16 a[196:197], v237 offset:0
v_cvt_pk_bf16_f32 v40, v40, v41
v_mfma_f32_16x16x32_bf16 v[72:75], a[232:235], v[136:139], v[72:75]
v_exp_f32 v45, v45
v_mfma_f32_16x16x32_bf16 v[72:75], a[236:239], v[140:143], v[72:75]
v_add_f32 v249, v249, v42
v_add_f32 v249, v249, v43
v_mfma_f32_16x16x32_bf16 v[76:79], a[240:243], v[128:131], v[212:215]
v_exp_f32 v46, v46
v_mfma_f32_16x16x32_bf16 v[76:79], a[244:247], v[132:135], v[76:79]
ds_read_b64_tr_b16 a[198:199], v237 offset:4096
v_cvt_pk_bf16_f32 v41, v42, v43
v_mfma_f32_16x16x32_bf16 v[76:79], a[248:251], v[136:139], v[76:79]
v_exp_f32 v47, v47
v_mfma_f32_16x16x32_bf16 v[76:79], a[252:255], v[140:143], v[76:79]
buffer_load_dwordx4 v244, s[4:7], s20 offen offset:2048 nt lds
v_add_f32 v249, v249, v44
v_mfma_f32_16x16x32_bf16 v[80:83], a[224:227], v[144:147], v[216:219]
s_add_u32 s20, s20, 0x2000
v_exp_f32 v48, v48
v_mfma_f32_16x16x32_bf16 v[80:83], a[228:231], v[148:151], v[80:83]
ds_read_b64_tr_b16 a[200:201], v238 offset:0
v_add_f32 v249, v249, v45
v_mfma_f32_16x16x32_bf16 v[80:83], a[232:235], v[152:155], v[80:83]
v_exp_f32 v49, v49
v_mfma_f32_16x16x32_bf16 v[80:83], a[236:239], v[156:159], v[80:83]
v_cvt_pk_bf16_f32 v42, v44, v45
v_add_f32 v249, v249, v46
v_mfma_f32_16x16x32_bf16 v[84:87], a[240:243], v[144:147], v[216:219]
v_exp_f32 v50, v50
v_mfma_f32_16x16x32_bf16 v[84:87], a[244:247], v[148:151], v[84:87]
ds_read_b64_tr_b16 a[202:203], v238 offset:4096
v_add_f32 v249, v249, v47
v_mfma_f32_16x16x32_bf16 v[84:87], a[248:251], v[152:155], v[84:87]
s_add_u32 m0, s22, 0xe000
v_exp_f32 v51, v51
v_mfma_f32_16x16x32_bf16 v[84:87], a[252:255], v[156:159], v[84:87]
buffer_load_dwordx4 v244, s[8:11], s21 offen nt lds
v_cvt_pk_bf16_f32 v43, v46, v47
v_mfma_f32_16x16x32_bf16 v[88:91], a[224:227], v[160:163], v[220:223]
v_exp_f32 v52, v52
v_mfma_f32_16x16x32_bf16 v[88:91], a[228:231], v[164:167], v[88:91]
ds_read_b64_tr_b16 a[204:205], v239 offset:0
v_add_f32 v250, v250, v48
v_mfma_f32_16x16x32_bf16 v[88:91], a[232:235], v[168:171], v[88:91]
v_exp_f32 v53, v53
v_mfma_f32_16x16x32_bf16 v[88:91], a[236:239], v[172:175], v[88:91]
v_add_f32 v250, v250, v49
v_cvt_pk_bf16_f32 v48, v48, v49
v_mfma_f32_16x16x32_bf16 v[92:95], a[240:243], v[160:163], v[220:223]
v_exp_f32 v54, v54
v_mfma_f32_16x16x32_bf16 v[92:95], a[244:247], v[164:167], v[92:95]
ds_read_b64_tr_b16 a[206:207], v239 offset:4096
v_add_f32 v250, v250, v50
v_mfma_f32_16x16x32_bf16 v[92:95], a[248:251], v[168:171], v[92:95]
v_exp_f32 v55, v55
v_mfma_f32_16x16x32_bf16 v[92:95], a[252:255], v[172:175], v[92:95]
buffer_load_dwordx4 v244, s[8:11], s21 offen offset:2048 nt lds
v_add_f32 v250, v250, v51
v_mfma_f32_16x16x32_bf16 v[96:99], a[224:227], v[176:179], v[224:227]
s_add_u32 s21, s21, 0x2000
v_exp_f32 v56, v56
v_mfma_f32_16x16x32_bf16 v[96:99], a[228:231], v[180:183], v[96:99]
ds_read_b64_tr_b16 a[208:209], v240 offset:0
v_cvt_pk_bf16_f32 v49, v50, v51
v_mfma_f32_16x16x32_bf16 v[96:99], a[232:235], v[184:187], v[96:99]
v_exp_f32 v57, v57
v_mfma_f32_16x16x32_bf16 v[96:99], a[236:239], v[188:191], v[96:99]
v_add_f32 v250, v250, v52
v_add_f32 v250, v250, v53
v_mfma_f32_16x16x32_bf16 v[100:103], a[240:243], v[176:179], v[224:227]
v_exp_f32 v58, v58
v_mfma_f32_16x16x32_bf16 v[100:103], a[244:247], v[180:183], v[100:103]
ds_read_b64_tr_b16 a[210:211], v240 offset:4096
v_cvt_pk_bf16_f32 v50, v52, v53
v_mfma_f32_16x16x32_bf16 v[100:103], a[248:251], v[184:187], v[100:103]
v_exp_f32 v59, v59
v_mfma_f32_16x16x32_bf16 v[100:103], a[252:255], v[188:191], v[100:103]
v_add_f32 v250, v250, v54
v_add_f32 v250, v250, v55
v_mfma_f32_16x16x32_bf16 v[104:107], a[224:227], v[192:195], v[228:231]
v_exp_f32 v60, v60
v_mfma_f32_16x16x32_bf16 v[104:107], a[228:231], v[196:199], v[104:107]
ds_read_b64_tr_b16 a[212:213], v241 offset:0
v_cvt_pk_bf16_f32 v51, v54, v55
v_mfma_f32_16x16x32_bf16 v[104:107], a[232:235], v[200:203], v[104:107]
v_exp_f32 v61, v61
v_mfma_f32_16x16x32_bf16 v[104:107], a[236:239], v[204:207], v[104:107]
v_add_f32 v251, v251, v56
v_add_f32 v251, v251, v57
v_mfma_f32_16x16x32_bf16 v[108:111], a[240:243], v[192:195], v[228:231]
v_exp_f32 v62, v62
v_mfma_f32_16x16x32_bf16 v[108:111], a[244:247], v[196:199], v[108:111]
ds_read_b64_tr_b16 a[214:215], v241 offset:4096
v_cvt_pk_bf16_f32 v56, v56, v57
v_mfma_f32_16x16x32_bf16 v[108:111], a[248:251], v[200:203], v[108:111]
v_exp_f32 v63, v63
v_mfma_f32_16x16x32_bf16 v[108:111], a[252:255], v[204:207], v[108:111]
s_waitcnt lgkmcnt(10)
v_add_f32 v251, v251, v58
v_add_f32 v251, v251, v59
v_cvt_pk_bf16_f32 v57, v58, v59
v_add_f32 v251, v251, v60
v_add_f32 v251, v251, v61
v_cvt_pk_bf16_f32 v58, v60, v61
v_add_f32 v251, v251, v62
v_add_f32 v251, v251, v63
v_cvt_pk_bf16_f32 v59, v62, v63
v_mfma_f32_16x16x32_bf16 a[0:3], a[192:195], v[16:19], a[0:3]
v_exp_f32 v64, v64
v_mfma_f32_16x16x32_bf16 a[32:35], a[192:195], v[24:27], a[32:35]
ds_read_b64_tr_b16 a[216:217], v242 offset:0
v_add_f32 v246, v246, v64
v_mfma_f32_16x16x32_bf16 a[64:67], a[192:195], v[32:35], a[64:67]
v_exp_f32 v65, v65
v_mfma_f32_16x16x32_bf16 a[96:99], a[192:195], v[40:43], a[96:99]
ds_read_b128 v[0:3], v7 offset:3072
v_add_f32 v246, v246, v65
v_mfma_f32_16x16x32_bf16 a[128:131], a[192:195], v[48:51], a[128:131]
v_exp_f32 v66, v66
v_mfma_f32_16x16x32_bf16 a[160:163], a[192:195], v[56:59], a[160:163]
s_waitcnt lgkmcnt(10)
ds_read_b64_tr_b16 a[218:219], v242 offset:4096
v_cvt_pk_bf16_f32 v64, v64, v65
v_mfma_f32_16x16x32_bf16 a[4:7], a[196:199], v[16:19], a[4:7]
v_exp_f32 v67, v67
v_mfma_f32_16x16x32_bf16 a[36:39], a[196:199], v[24:27], a[36:39]
v_add_f32 v246, v246, v66
v_add_f32 v246, v246, v67
v_mfma_f32_16x16x32_bf16 a[68:71], a[196:199], v[32:35], a[68:71]
s_cmp_lt_u32 s28, 6
v_exp_f32 v68, v68
v_mfma_f32_16x16x32_bf16 a[100:103], a[196:199], v[40:43], a[100:103]
ds_read_b64_tr_b16 a[220:221], v243 offset:0
v_cvt_pk_bf16_f32 v65, v66, v67
v_mfma_f32_16x16x32_bf16 a[132:135], a[196:199], v[48:51], a[132:135]
s_cselect_b32 s33, s32, s42
v_exp_f32 v69, v69
v_mfma_f32_16x16x32_bf16 a[164:167], a[196:199], v[56:59], a[164:167]
s_waitcnt lgkmcnt(10)
v_add_f32 v246, v246, v68
v_add_f32 v246, v246, v69
v_mfma_f32_16x16x32_bf16 a[8:11], a[200:203], v[16:19], a[8:11]
s_cmp_lt_u32 s28, 5
v_exp_f32 v70, v70
v_mfma_f32_16x16x32_bf16 a[40:43], a[200:203], v[24:27], a[40:43]
ds_read_b64_tr_b16 a[222:223], v243 offset:4096
v_cvt_pk_bf16_f32 v66, v68, v69
v_mfma_f32_16x16x32_bf16 a[72:75], a[200:203], v[32:35], a[72:75]
s_cselect_b32 s34, 0x1000, 0
v_exp_f32 v71, v71
v_mfma_f32_16x16x32_bf16 a[104:107], a[200:203], v[40:43], a[104:107]
v_add_f32 v246, v246, v70
v_add_f32 v246, v246, v71
v_mfma_f32_16x16x32_bf16 a[136:139], a[200:203], v[48:51], a[136:139]
v_exp_f32 v72, v72
v_mfma_f32_16x16x32_bf16 a[168:171], a[200:203], v[56:59], a[168:171]
s_waitcnt lgkmcnt(9)
ds_read_b128 a[224:227], v232 offset:16384
v_cvt_pk_bf16_f32 v67, v70, v71
v_mfma_f32_16x16x32_bf16 a[12:15], a[204:207], v[16:19], a[12:15]
v_exp_f32 v73, v73
v_mfma_f32_16x16x32_bf16 a[44:47], a[204:207], v[24:27], a[44:47]
ds_read_b128 a[228:231], v233 offset:16384
v_add_f32 v247, v247, v72
v_mfma_f32_16x16x32_bf16 a[76:79], a[204:207], v[32:35], a[76:79]
v_exp_f32 v74, v74
v_mfma_f32_16x16x32_bf16 a[108:111], a[204:207], v[40:43], a[108:111]
ds_read_b128 a[232:235], v234 offset:16384
v_add_f32 v247, v247, v73
v_mfma_f32_16x16x32_bf16 a[140:143], a[204:207], v[48:51], a[140:143]
s_waitcnt lgkmcnt(6)
v_exp_f32 v75, v75
v_mfma_f32_16x16x32_bf16 a[172:175], a[204:207], v[56:59], a[172:175]
s_waitcnt lgkmcnt(10)
buffer_store_dwordx4 v[0:3], v245, s[16:19], s33 offen sc1 nt
v_cvt_pk_bf16_f32 v72, v72, v73
v_mfma_f32_16x16x32_bf16 a[16:19], a[208:211], v[16:19], a[16:19]
s_add_u32 s32, s32, 0x400
v_exp_f32 v76, v76
v_mfma_f32_16x16x32_bf16 a[48:51], a[208:211], v[24:27], a[48:51]
ds_read_b128 a[236:239], v235 offset:16384
v_add_f32 v247, v247, v74
v_mfma_f32_16x16x32_bf16 a[80:83], a[208:211], v[32:35], a[80:83]
v_exp_f32 v77, v77
v_mfma_f32_16x16x32_bf16 a[112:115], a[208:211], v[40:43], a[112:115]
v_add_u32 v7, s34, v7
v_add_f32 v247, v247, v75
v_mfma_f32_16x16x32_bf16 a[144:147], a[208:211], v[48:51], a[144:147]
v_exp_f32 v78, v78
v_mfma_f32_16x16x32_bf16 a[176:179], a[208:211], v[56:59], a[176:179]
s_waitcnt lgkmcnt(9)
ds_read_b128 a[240:243], v232 offset:20480
v_cvt_pk_bf16_f32 v73, v74, v75
v_mfma_f32_16x16x32_bf16 a[20:23], a[212:215], v[16:19], a[20:23]
v_exp_f32 v79, v79
v_mfma_f32_16x16x32_bf16 a[52:55], a[212:215], v[24:27], a[52:55]
v_add_f32 v247, v247, v76
v_add_f32 v247, v247, v77
v_mfma_f32_16x16x32_bf16 a[84:87], a[212:215], v[32:35], a[84:87]
v_exp_f32 v80, v80
v_mfma_f32_16x16x32_bf16 a[116:119], a[212:215], v[40:43], a[116:119]
ds_read_b128 a[244:247], v233 offset:20480
v_cvt_pk_bf16_f32 v74, v76, v77
v_mfma_f32_16x16x32_bf16 a[148:151], a[212:215], v[48:51], a[148:151]
v_exp_f32 v81, v81
v_mfma_f32_16x16x32_bf16 a[180:183], a[212:215], v[56:59], a[180:183]
s_waitcnt lgkmcnt(8)
v_add_f32 v247, v247, v78
v_add_f32 v247, v247, v79
v_mfma_f32_16x16x32_bf16 a[24:27], a[216:219], v[16:19], a[24:27]
v_exp_f32 v82, v82
v_mfma_f32_16x16x32_bf16 a[56:59], a[216:219], v[24:27], a[56:59]
ds_read_b128 a[248:251], v234 offset:20480
v_cvt_pk_bf16_f32 v75, v78, v79
v_mfma_f32_16x16x32_bf16 a[88:91], a[216:219], v[32:35], a[88:91]
v_exp_f32 v83, v83
v_mfma_f32_16x16x32_bf16 a[120:123], a[216:219], v[40:43], a[120:123]
v_add_f32 v248, v248, v80
v_add_f32 v248, v248, v81
v_mfma_f32_16x16x32_bf16 a[152:155], a[216:219], v[48:51], a[152:155]
v_exp_f32 v84, v84
v_mfma_f32_16x16x32_bf16 a[184:187], a[216:219], v[56:59], a[184:187]
s_waitcnt lgkmcnt(7)
ds_read_b128 a[252:255], v235 offset:20480
v_cvt_pk_bf16_f32 v80, v80, v81
v_mfma_f32_16x16x32_bf16 a[28:31], a[220:223], v[16:19], a[28:31]
v_exp_f32 v85, v85
v_mfma_f32_16x16x32_bf16 a[60:63], a[220:223], v[24:27], a[60:63]
v_add_f32 v248, v248, v82
v_add_f32 v248, v248, v83
v_mfma_f32_16x16x32_bf16 a[92:95], a[220:223], v[32:35], a[92:95]
v_exp_f32 v86, v86
v_mfma_f32_16x16x32_bf16 a[124:127], a[220:223], v[40:43], a[124:127]
v_cvt_pk_bf16_f32 v81, v82, v83
v_add_f32 v248, v248, v84
v_mfma_f32_16x16x32_bf16 a[156:159], a[220:223], v[48:51], a[156:159]
v_exp_f32 v87, v87
v_mfma_f32_16x16x32_bf16 a[188:191], a[220:223], v[56:59], a[188:191]
s_waitcnt lgkmcnt(0)
v_add_f32 v248, v248, v85
v_cvt_pk_bf16_f32 v82, v84, v85
v_mfma_f32_16x16x32_bf16 v[16:19], a[224:227], v[112:115], v[208:211]
v_exp_f32 v88, v88
v_mfma_f32_16x16x32_bf16 v[16:19], a[228:231], v[116:119], v[16:19]
v_add_f32 v248, v248, v86
v_add_f32 v248, v248, v87
v_mfma_f32_16x16x32_bf16 v[16:19], a[232:235], v[120:123], v[16:19]
s_waitcnt lgkmcnt(0) vmcnt(11)
s_barrier
v_exp_f32 v89, v89
v_mfma_f32_16x16x32_bf16 v[16:19], a[236:239], v[124:127], v[16:19]
ds_read_b64_tr_b16 a[192:193], v236 offset:8192
v_cvt_pk_bf16_f32 v83, v86, v87
v_mfma_f32_16x16x32_bf16 v[20:23], a[240:243], v[112:115], v[208:211]
v_exp_f32 v90, v90
v_mfma_f32_16x16x32_bf16 v[20:23], a[244:247], v[116:119], v[20:23]
ds_read_b64_tr_b16 a[194:195], v236 offset:12288
v_add_f32 v249, v249, v88
v_mfma_f32_16x16x32_bf16 v[20:23], a[248:251], v[120:123], v[20:23]
s_add_u32 m0, s22, 0x4000
v_exp_f32 v91, v91
v_mfma_f32_16x16x32_bf16 v[20:23], a[252:255], v[124:127], v[20:23]
buffer_load_dwordx4 v244, s[4:7], s20 offen nt lds
v_add_f32 v249, v249, v89
v_mfma_f32_16x16x32_bf16 v[24:27], a[224:227], v[128:131], v[212:215]
v_exp_f32 v92, v92
v_mfma_f32_16x16x32_bf16 v[24:27], a[228:231], v[132:135], v[24:27]
ds_read_b64_tr_b16 a[196:197], v237 offset:8192
v_cvt_pk_bf16_f32 v88, v88, v89
v_mfma_f32_16x16x32_bf16 v[24:27], a[232:235], v[136:139], v[24:27]
v_exp_f32 v93, v93
v_mfma_f32_16x16x32_bf16 v[24:27], a[236:239], v[140:143], v[24:27]
v_add_f32 v249, v249, v90
v_add_f32 v249, v249, v91
v_mfma_f32_16x16x32_bf16 v[28:31], a[240:243], v[128:131], v[212:215]
v_exp_f32 v94, v94
v_mfma_f32_16x16x32_bf16 v[28:31], a[244:247], v[132:135], v[28:31]
ds_read_b64_tr_b16 a[198:199], v237 offset:12288
v_cvt_pk_bf16_f32 v89, v90, v91
v_mfma_f32_16x16x32_bf16 v[28:31], a[248:251], v[136:139], v[28:31]
v_exp_f32 v95, v95
v_mfma_f32_16x16x32_bf16 v[28:31], a[252:255], v[140:143], v[28:31]
buffer_load_dwordx4 v244, s[4:7], s20 offen offset:2048 nt lds
v_add_f32 v249, v249, v92
v_mfma_f32_16x16x32_bf16 v[32:35], a[224:227], v[144:147], v[216:219]
s_add_u32 s20, s20, 0x2000
v_exp_f32 v96, v96
v_mfma_f32_16x16x32_bf16 v[32:35], a[228:231], v[148:151], v[32:35]
ds_read_b64_tr_b16 a[200:201], v238 offset:8192
v_add_f32 v249, v249, v93
v_mfma_f32_16x16x32_bf16 v[32:35], a[232:235], v[152:155], v[32:35]
v_exp_f32 v97, v97
v_mfma_f32_16x16x32_bf16 v[32:35], a[236:239], v[156:159], v[32:35]
v_cvt_pk_bf16_f32 v90, v92, v93
v_add_f32 v249, v249, v94
v_mfma_f32_16x16x32_bf16 v[36:39], a[240:243], v[144:147], v[216:219]
v_exp_f32 v98, v98
v_mfma_f32_16x16x32_bf16 v[36:39], a[244:247], v[148:151], v[36:39]
ds_read_b64_tr_b16 a[202:203], v238 offset:12288
v_add_f32 v249, v249, v95
v_mfma_f32_16x16x32_bf16 v[36:39], a[248:251], v[152:155], v[36:39]
s_add_u32 m0, s22, 0x8000
v_exp_f32 v99, v99
v_mfma_f32_16x16x32_bf16 v[36:39], a[252:255], v[156:159], v[36:39]
buffer_load_dwordx4 v244, s[8:11], s21 offen nt lds
v_cvt_pk_bf16_f32 v91, v94, v95
v_mfma_f32_16x16x32_bf16 v[40:43], a[224:227], v[160:163], v[220:223]
v_exp_f32 v100, v100
v_mfma_f32_16x16x32_bf16 v[40:43], a[228:231], v[164:167], v[40:43]
ds_read_b64_tr_b16 a[204:205], v239 offset:8192
v_add_f32 v250, v250, v96
v_mfma_f32_16x16x32_bf16 v[40:43], a[232:235], v[168:171], v[40:43]
v_exp_f32 v101, v101
v_mfma_f32_16x16x32_bf16 v[40:43], a[236:239], v[172:175], v[40:43]
v_add_f32 v250, v250, v97
v_cvt_pk_bf16_f32 v96, v96, v97
v_mfma_f32_16x16x32_bf16 v[44:47], a[240:243], v[160:163], v[220:223]
v_exp_f32 v102, v102
v_mfma_f32_16x16x32_bf16 v[44:47], a[244:247], v[164:167], v[44:47]
ds_read_b64_tr_b16 a[206:207], v239 offset:12288
v_add_f32 v250, v250, v98
v_mfma_f32_16x16x32_bf16 v[44:47], a[248:251], v[168:171], v[44:47]
v_exp_f32 v103, v103
v_mfma_f32_16x16x32_bf16 v[44:47], a[252:255], v[172:175], v[44:47]
buffer_load_dwordx4 v244, s[8:11], s21 offen offset:2048 nt lds
v_add_f32 v250, v250, v99
v_mfma_f32_16x16x32_bf16 v[48:51], a[224:227], v[176:179], v[224:227]
s_add_u32 s21, s21, 0x2000
v_exp_f32 v104, v104
v_mfma_f32_16x16x32_bf16 v[48:51], a[228:231], v[180:183], v[48:51]
ds_read_b64_tr_b16 a[208:209], v240 offset:8192
v_cvt_pk_bf16_f32 v97, v98, v99
v_mfma_f32_16x16x32_bf16 v[48:51], a[232:235], v[184:187], v[48:51]
v_exp_f32 v105, v105
v_mfma_f32_16x16x32_bf16 v[48:51], a[236:239], v[188:191], v[48:51]
v_add_f32 v250, v250, v100
v_add_f32 v250, v250, v101
v_mfma_f32_16x16x32_bf16 v[52:55], a[240:243], v[176:179], v[224:227]
v_exp_f32 v106, v106
v_mfma_f32_16x16x32_bf16 v[52:55], a[244:247], v[180:183], v[52:55]
ds_read_b64_tr_b16 a[210:211], v240 offset:12288
v_cvt_pk_bf16_f32 v98, v100, v101
v_mfma_f32_16x16x32_bf16 v[52:55], a[248:251], v[184:187], v[52:55]
v_exp_f32 v107, v107
v_mfma_f32_16x16x32_bf16 v[52:55], a[252:255], v[188:191], v[52:55]
v_add_f32 v250, v250, v102
v_add_f32 v250, v250, v103
v_mfma_f32_16x16x32_bf16 v[56:59], a[224:227], v[192:195], v[228:231]
v_exp_f32 v108, v108
v_mfma_f32_16x16x32_bf16 v[56:59], a[228:231], v[196:199], v[56:59]
ds_read_b64_tr_b16 a[212:213], v241 offset:8192
v_cvt_pk_bf16_f32 v99, v102, v103
v_mfma_f32_16x16x32_bf16 v[56:59], a[232:235], v[200:203], v[56:59]
v_exp_f32 v109, v109
v_mfma_f32_16x16x32_bf16 v[56:59], a[236:239], v[204:207], v[56:59]
v_add_f32 v251, v251, v104
v_add_f32 v251, v251, v105
v_mfma_f32_16x16x32_bf16 v[60:63], a[240:243], v[192:195], v[228:231]
v_exp_f32 v110, v110
v_mfma_f32_16x16x32_bf16 v[60:63], a[244:247], v[196:199], v[60:63]
ds_read_b64_tr_b16 a[214:215], v241 offset:12288
v_cvt_pk_bf16_f32 v104, v104, v105
v_mfma_f32_16x16x32_bf16 v[60:63], a[248:251], v[200:203], v[60:63]
v_exp_f32 v111, v111
v_mfma_f32_16x16x32_bf16 v[60:63], a[252:255], v[204:207], v[60:63]
s_waitcnt lgkmcnt(10)
v_add_f32 v251, v251, v106
v_add_f32 v251, v251, v107
v_cvt_pk_bf16_f32 v105, v106, v107
v_add_f32 v251, v251, v108
v_add_f32 v251, v251, v109
v_cvt_pk_bf16_f32 v106, v108, v109
v_add_f32 v251, v251, v110
v_add_f32 v251, v251, v111
v_cvt_pk_bf16_f32 v107, v110, v111
s_add_u32 s28, s28, 1
s_branch L_loopo
L_tail:
s_getpc_b64 s[64:65]
L_pfb:
s_sub_u32 s64, s64, L_pfb-L_loopo
s_subb_u32 s65, s65, 0
s_lshl_b32 s66, s25, 12
s_add_u32 s64, s64, s66
s_addc_u32 s65, s65, 0
v_mbcnt_lo_u32_b32 v12, -1, 0
v_mbcnt_hi_u32_b32 v12, -1, v12
v_lshlrev_b32 v12, 6, v12
v_mov_b32 v13, s65
v_add_co_u32 v12, vcc, s64, v12
s_nop 1
v_addc_co_u32 v13, vcc, 0, v13, vcc
global_load_dword v255, v[12:13], off
v_add_co_u32 v12, vcc, 0x4000, v12
s_nop 1
v_addc_co_u32 v13, vcc, 0, v13, vcc
global_load_dword v255, v[12:13], off
v_mfma_f32_16x16x32_bf16 a[0:3], a[192:195], v[16:19], a[0:3]
v_exp_f32 v64, v64
v_mfma_f32_16x16x32_bf16 a[32:35], a[192:195], v[24:27], a[32:35]
ds_read_b64_tr_b16 a[216:217], v242 offset:16384
v_add_f32 v246, v246, v64
v_mfma_f32_16x16x32_bf16 a[64:67], a[192:195], v[32:35], a[64:67]
v_exp_f32 v65, v65
v_mfma_f32_16x16x32_bf16 a[96:99], a[192:195], v[40:43], a[96:99]
v_exp_f32 v66, v66
v_mfma_f32_16x16x32_bf16 a[128:131], a[192:195], v[48:51], a[128:131]
v_add_f32 v246, v246, v65
v_cvt_pk_bf16_f32 v64, v64, v65
v_mfma_f32_16x16x32_bf16 a[160:163], a[192:195], v[56:59], a[160:163]
s_waitcnt lgkmcnt(9)
ds_read_b64_tr_b16 a[218:219], v242 offset:20480
v_add_f32 v246, v246, v66
v_mfma_f32_16x16x32_bf16 a[4:7], a[196:199], v[16:19], a[4:7]
v_exp_f32 v67, v67
v_mfma_f32_16x16x32_bf16 a[36:39], a[196:199], v[24:27], a[36:39]
v_exp_f32 v68, v68
v_mfma_f32_16x16x32_bf16 a[68:71], a[196:199], v[32:35], a[68:71]
s_waitcnt vmcnt(12)
s_barrier
v_exp_f32 v69, v69
v_mfma_f32_16x16x32_bf16 a[100:103], a[196:199], v[40:43], a[100:103]
ds_read_b64_tr_b16 a[220:221], v243 offset:16384
v_add_f32 v246, v246, v67
v_mfma_f32_16x16x32_bf16 a[132:135], a[196:199], v[48:51], a[132:135]
v_exp_f32 v70, v70
v_mfma_f32_16x16x32_bf16 a[164:167], a[196:199], v[56:59], a[164:167]
s_waitcnt lgkmcnt(9)
ds_read_b64_tr_b16 a[224:225], v236 offset:24576
v_cvt_pk_bf16_f32 v65, v66, v67
v_add_f32 v246, v246, v68
v_mfma_f32_16x16x32_bf16 a[8:11], a[200:203], v[16:19], a[8:11]
v_exp_f32 v71, v71
v_mfma_f32_16x16x32_bf16 a[40:43], a[200:203], v[24:27], a[40:43]
ds_read_b64_tr_b16 a[222:223], v243 offset:20480
ds_read_b64_tr_b16 a[226:227], v236 offset:28672
v_add_f32 v246, v246, v69
v_cvt_pk_bf16_f32 v66, v68, v69
v_mfma_f32_16x16x32_bf16 a[72:75], a[200:203], v[32:35], a[72:75]
v_exp_f32 v72, v72
v_mfma_f32_16x16x32_bf16 a[104:107], a[200:203], v[40:43], a[104:107]
ds_read_b64_tr_b16 a[228:229], v237 offset:24576
v_add_f32 v246, v246, v70
v_mfma_f32_16x16x32_bf16 a[136:139], a[200:203], v[48:51], a[136:139]
v_exp_f32 v73, v73
v_mfma_f32_16x16x32_bf16 a[168:171], a[200:203], v[56:59], a[168:171]
s_waitcnt lgkmcnt(11)
ds_read_b64_tr_b16 a[230:231], v237 offset:28672
v_add_f32 v246, v246, v71
v_cvt_pk_bf16_f32 v67, v70, v71
v_mfma_f32_16x16x32_bf16 a[12:15], a[204:207], v[16:19], a[12:15]
v_exp_f32 v74, v74
v_mfma_f32_16x16x32_bf16 a[44:47], a[204:207], v[24:27], a[44:47]
ds_read_b64_tr_b16 a[232:233], v238 offset:24576
v_add_f32 v247, v247, v72
v_mfma_f32_16x16x32_bf16 a[76:79], a[204:207], v[32:35], a[76:79]
v_exp_f32 v75, v75
v_mfma_f32_16x16x32_bf16 a[108:111], a[204:207], v[40:43], a[108:111]
ds_read_b64_tr_b16 a[234:235], v238 offset:28672
v_add_f32 v247, v247, v73
v_cvt_pk_bf16_f32 v72, v72, v73
v_mfma_f32_16x16x32_bf16 a[140:143], a[204:207], v[48:51], a[140:143]
v_exp_f32 v76, v76
v_mfma_f32_16x16x32_bf16 a[172:175], a[204:207], v[56:59], a[172:175]
s_waitcnt lgkmcnt(12)
ds_read_b64_tr_b16 a[236:237], v239 offset:24576
v_add_f32 v247, v247, v74
v_mfma_f32_16x16x32_bf16 a[16:19], a[208:211], v[16:19], a[16:19]
s_waitcnt lgkmcnt(8)
v_exp_f32 v77, v77
v_mfma_f32_16x16x32_bf16 a[48:51], a[208:211], v[24:27], a[48:51]
ds_read_b64_tr_b16 a[238:239], v239 offset:28672
v_exp_f32 v78, v78
v_mfma_f32_16x16x32_bf16 a[80:83], a[208:211], v[32:35], a[80:83]
v_exp_f32 v79, v79
v_mfma_f32_16x16x32_bf16 a[112:115], a[208:211], v[40:43], a[112:115]
ds_read_b64_tr_b16 a[240:241], v240 offset:24576
v_add_f32 v247, v247, v75
v_cvt_pk_bf16_f32 v73, v74, v75
v_add_f32 v247, v247, v76
v_mfma_f32_16x16x32_bf16 a[144:147], a[208:211], v[48:51], a[144:147]
v_exp_f32 v80, v80
v_mfma_f32_16x16x32_bf16 a[176:179], a[208:211], v[56:59], a[176:179]
s_waitcnt lgkmcnt(13)
ds_read_b64_tr_b16 a[242:243], v240 offset:28672
v_add_f32 v247, v247, v77
v_cvt_pk_bf16_f32 v74, v76, v77
v_add_f32 v247, v247, v78
v_mfma_f32_16x16x32_bf16 a[20:23], a[212:215], v[16:19], a[20:23]
v_exp_f32 v81, v81
v_mfma_f32_16x16x32_bf16 a[52:55], a[212:215], v[24:27], a[52:55]
ds_read_b64_tr_b16 a[244:245], v241 offset:24576
v_add_f32 v247, v247, v79
v_cvt_pk_bf16_f32 v75, v78, v79
v_mfma_f32_16x16x32_bf16 a[84:87], a[212:215], v[32:35], a[84:87]
v_exp_f32 v82, v82
v_mfma_f32_16x16x32_bf16 a[116:119], a[212:215], v[40:43], a[116:119]
ds_read_b64_tr_b16 a[246:247], v241 offset:28672
v_add_f32 v248, v248, v80
v_mfma_f32_16x16x32_bf16 a[148:151], a[212:215], v[48:51], a[148:151]
v_exp_f32 v83, v83
v_mfma_f32_16x16x32_bf16 a[180:183], a[212:215], v[56:59], a[180:183]
s_waitcnt lgkmcnt(14)
ds_read_b64_tr_b16 a[248:249], v242 offset:24576
v_add_f32 v248, v248, v81
v_cvt_pk_bf16_f32 v80, v80, v81
v_mfma_f32_16x16x32_bf16 a[24:27], a[216:219], v[16:19], a[24:27]
s_waitcnt lgkmcnt(8)
v_exp_f32 v84, v84
v_mfma_f32_16x16x32_bf16 a[56:59], a[216:219], v[24:27], a[56:59]
ds_read_b64_tr_b16 a[250:251], v242 offset:28672
v_exp_f32 v85, v85
v_mfma_f32_16x16x32_bf16 a[88:91], a[216:219], v[32:35], a[88:91]
v_exp_f32 v86, v86
v_mfma_f32_16x16x32_bf16 a[120:123], a[216:219], v[40:43], a[120:123]
ds_read_b64_tr_b16 a[252:253], v243 offset:24576
v_add_f32 v248, v248, v82
v_add_f32 v248, v248, v83
v_cvt_pk_bf16_f32 v81, v82, v83
v_mfma_f32_16x16x32_bf16 a[152:155], a[216:219], v[48:51], a[152:155]
v_exp_f32 v87, v87
v_mfma_f32_16x16x32_bf16 a[184:187], a[216:219], v[56:59], a[184:187]
s_waitcnt lgkmcnt(13)
ds_read_b64_tr_b16 a[254:255], v243 offset:28672
v_add_f32 v248, v248, v84
v_add_f32 v248, v248, v85
v_cvt_pk_bf16_f32 v82, v84, v85
v_mfma_f32_16x16x32_bf16 a[28:31], a[220:223], v[16:19], a[28:31]
v_exp_f32 v88, v88
v_mfma_f32_16x16x32_bf16 a[60:63], a[220:223], v[24:27], a[60:63]
v_exp_f32 v89, v89
v_mfma_f32_16x16x32_bf16 a[92:95], a[220:223], v[32:35], a[92:95]
v_exp_f32 v90, v90
v_mfma_f32_16x16x32_bf16 a[124:127], a[220:223], v[40:43], a[124:127]
v_add_f32 v248, v248, v86
v_add_f32 v248, v248, v87
v_cvt_pk_bf16_f32 v83, v86, v87
v_mfma_f32_16x16x32_bf16 a[156:159], a[220:223], v[48:51], a[156:159]
v_exp_f32 v91, v91
v_mfma_f32_16x16x32_bf16 a[188:191], a[220:223], v[56:59], a[188:191]
s_waitcnt lgkmcnt(0)
v_exp_f32 v92, v92
v_mfma_f32_16x16x32_bf16 a[0:3], a[224:227], v[64:67], a[0:3]
v_add_f32 v249, v249, v88
v_add_f32 v249, v249, v89
v_cvt_pk_bf16_f32 v88, v88, v89
v_add_f32 v249, v249, v90
v_mfma_f32_16x16x32_bf16 a[4:7], a[228:231], v[64:67], a[4:7]
v_exp_f32 v93, v93
v_mfma_f32_16x16x32_bf16 a[8:11], a[232:235], v[64:67], a[8:11]
v_add_f32 v249, v249, v91
v_cvt_pk_bf16_f32 v89, v90, v91
v_mfma_f32_16x16x32_bf16 a[12:15], a[236:239], v[64:67], a[12:15]
v_exp_f32 v94, v94
v_mfma_f32_16x16x32_bf16 a[16:19], a[240:243], v[64:67], a[16:19]
v_exp_f32 v95, v95
v_mfma_f32_16x16x32_bf16 a[20:23], a[244:247], v[64:67], a[20:23]
v_add_f32 v249, v249, v92
v_add_f32 v249, v249, v93
v_cvt_pk_bf16_f32 v90, v92, v93
v_mfma_f32_16x16x32_bf16 a[24:27], a[248:251], v[64:67], a[24:27]
v_exp_f32 v96, v96
v_mfma_f32_16x16x32_bf16 a[28:31], a[252:255], v[64:67], a[28:31]
v_add_f32 v249, v249, v94
v_add_f32 v249, v249, v95
v_mfma_f32_16x16x32_bf16 a[32:35], a[224:227], v[72:75], a[32:35]
v_exp_f32 v97, v97
v_mfma_f32_16x16x32_bf16 a[36:39], a[228:231], v[72:75], a[36:39]
v_cvt_pk_bf16_f32 v91, v94, v95
v_add_f32 v250, v250, v96
v_mfma_f32_16x16x32_bf16 a[40:43], a[232:235], v[72:75], a[40:43]
v_exp_f32 v98, v98
v_mfma_f32_16x16x32_bf16 a[44:47], a[236:239], v[72:75], a[44:47]
v_exp_f32 v99, v99
v_mfma_f32_16x16x32_bf16 a[48:51], a[240:243], v[72:75], a[48:51]
v_add_f32 v250, v250, v97
v_cvt_pk_bf16_f32 v96, v96, v97
v_mfma_f32_16x16x32_bf16 a[52:55], a[244:247], v[72:75], a[52:55]
v_exp_f32 v100, v100
v_mfma_f32_16x16x32_bf16 a[56:59], a[248:251], v[72:75], a[56:59]
v_add_f32 v250, v250, v98
v_add_f32 v250, v250, v99
v_mfma_f32_16x16x32_bf16 a[60:63], a[252:255], v[72:75], a[60:63]
v_exp_f32 v101, v101
v_mfma_f32_16x16x32_bf16 a[64:67], a[224:227], v[80:83], a[64:67]
v_exp_f32 v102, v102
v_mfma_f32_16x16x32_bf16 a[68:71], a[228:231], v[80:83], a[68:71]
v_cvt_pk_bf16_f32 v97, v98, v99
v_add_f32 v250, v250, v100
v_mfma_f32_16x16x32_bf16 a[72:75], a[232:235], v[80:83], a[72:75]
v_exp_f32 v103, v103
v_mfma_f32_16x16x32_bf16 a[76:79], a[236:239], v[80:83], a[76:79]
v_add_f32 v250, v250, v101
v_cvt_pk_bf16_f32 v98, v100, v101
v_mfma_f32_16x16x32_bf16 a[80:83], a[240:243], v[80:83], a[80:83]
v_exp_f32 v104, v104
v_mfma_f32_16x16x32_bf16 a[84:87], a[244:247], v[80:83], a[84:87]
v_add_f32 v250, v250, v102
v_add_f32 v250, v250, v103
v_mfma_f32_16x16x32_bf16 a[88:91], a[248:251], v[80:83], a[88:91]
v_exp_f32 v105, v105
v_mfma_f32_16x16x32_bf16 a[92:95], a[252:255], v[80:83], a[92:95]
v_exp_f32 v106, v106
v_mfma_f32_16x16x32_bf16 a[96:99], a[224:227], v[88:91], a[96:99]
v_cvt_pk_bf16_f32 v99, v102, v103
v_add_f32 v251, v251, v104
v_mfma_f32_16x16x32_bf16 a[100:103], a[228:231], v[88:91], a[100:103]
v_exp_f32 v107, v107
v_mfma_f32_16x16x32_bf16 a[104:107], a[232:235], v[88:91], a[104:107]
v_add_f32 v251, v251, v105
v_cvt_pk_bf16_f32 v104, v104, v105
v_mfma_f32_16x16x32_bf16 a[108:111], a[236:239], v[88:91], a[108:111]
v_exp_f32 v108, v108
v_mfma_f32_16x16x32_bf16 a[112:115], a[240:243], v[88:91], a[112:115]
v_exp_f32 v109, v109
v_mfma_f32_16x16x32_bf16 a[116:119], a[244:247], v[88:91], a[116:119]
v_add_f32 v251, v251, v106
v_add_f32 v251, v251, v107
v_cvt_pk_bf16_f32 v105, v106, v107
v_mfma_f32_16x16x32_bf16 a[120:123], a[248:251], v[88:91], a[120:123]
v_exp_f32 v110, v110
v_mfma_f32_16x16x32_bf16 a[124:127], a[252:255], v[88:91], a[124:127]
v_add_f32 v251, v251, v108
v_add_f32 v251, v251, v109
v_mfma_f32_16x16x32_bf16 a[128:131], a[224:227], v[96:99], a[128:131]
v_exp_f32 v111, v111
v_mfma_f32_16x16x32_bf16 a[132:135], a[228:231], v[96:99], a[132:135]
v_cvt_pk_bf16_f32 v106, v108, v109
v_add_f32 v251, v251, v110
v_mfma_f32_16x16x32_bf16 a[136:139], a[232:235], v[96:99], a[136:139]
v_add_f32 v251, v251, v111
v_cvt_pk_bf16_f32 v107, v110, v111
v_mfma_f32_16x16x32_bf16 a[140:143], a[236:239], v[96:99], a[140:143]
v_mfma_f32_16x16x32_bf16 a[144:147], a[240:243], v[96:99], a[144:147]
v_mfma_f32_16x16x32_bf16 a[148:151], a[244:247], v[96:99], a[148:151]
v_mfma_f32_16x16x32_bf16 a[152:155], a[248:251], v[96:99], a[152:155]
v_mfma_f32_16x16x32_bf16 a[156:159], a[252:255], v[96:99], a[156:159]
v_mfma_f32_16x16x32_bf16 a[160:163], a[224:227], v[104:107], a[160:163]
v_mfma_f32_16x16x32_bf16 a[164:167], a[228:231], v[104:107], a[164:167]
v_mfma_f32_16x16x32_bf16 a[168:171], a[232:235], v[104:107], a[168:171]
v_mfma_f32_16x16x32_bf16 a[172:175], a[236:239], v[104:107], a[172:175]
v_mfma_f32_16x16x32_bf16 a[176:179], a[240:243], v[104:107], a[176:179]
v_mfma_f32_16x16x32_bf16 a[180:183], a[244:247], v[104:107], a[180:183]
v_mfma_f32_16x16x32_bf16 a[184:187], a[248:251], v[104:107], a[184:187]
v_mfma_f32_16x16x32_bf16 a[188:191], a[252:255], v[104:107], a[188:191]
s_mov_b32 s27, s26
s_mov_b32 s47, s39
s_add_u32 s30, s39, s44
s_cmp_eq_u32 s30, 0
s_cbranch_scc0 L_final
s_nop 3
v_add_u32 v104, s40, v232
v_add_u32 v105, s40, v233
v_add_u32 v106, s40, v234
v_add_u32 v107, s40, v235
ds_read_b128 v[112:115], v104 offset:0
ds_read_b128 v[116:119], v105 offset:0
ds_read_b128 v[120:123], v106 offset:0
ds_read_b128 v[124:127], v107 offset:0
ds_read_b128 v[128:131], v104 offset:4096
ds_read_b128 v[132:135], v105 offset:4096
ds_read_b128 v[136:139], v106 offset:4096
ds_read_b128 v[140:143], v107 offset:4096
ds_read_b128 a[192:195], v232 offset:0
ds_read_b128 a[196:199], v233 offset:0
ds_read_b128 a[200:203], v234 offset:0
ds_read_b128 a[204:207], v235 offset:0
ds_read_b128 a[208:211], v232 offset:4096
ds_read_b128 a[212:215], v233 offset:4096
ds_read_b128 a[216:219], v234 offset:4096
s_waitcnt lgkmcnt(13)
ds_read_b128 a[220:223], v235 offset:4096
v_mov_b32 v8, v246
v_mov_b32 v9, v247
v_mov_b32 v10, v248
v_mov_b32 v11, v249
v_mov_b32 v12, v250
v_mov_b32 v13, v251
s_nop 0
v_permlane16_swap_b32 v246, v8
v_permlane16_swap_b32 v247, v9
v_permlane16_swap_b32 v248, v10
v_permlane16_swap_b32 v249, v11
v_permlane16_swap_b32 v250, v12
v_permlane16_swap_b32 v251, v13
s_nop 0
v_add_f32 v246, v246, v8
v_add_f32 v247, v247, v9
v_add_f32 v248, v248, v10
v_add_f32 v249, v249, v11
v_add_f32 v250, v250, v12
v_add_f32 v251, v251, v13
v_mov_b32 v8, v246
v_mov_b32 v9, v247
v_mov_b32 v10, v248
v_mov_b32 v11, v249
v_mov_b32 v12, v250
v_mov_b32 v13, v251
s_nop 0
v_permlane32_swap_b32 v246, v8
v_permlane32_swap_b32 v247, v9
v_permlane32_swap_b32 v248, v10
v_permlane32_swap_b32 v249, v11
v_permlane32_swap_b32 v250, v12
v_permlane32_swap_b32 v251, v13
s_nop 0
v_add_f32 v246, v246, v8
v_add_f32 v247, v247, v9
v_add_f32 v248, v248, v10
v_add_f32 v249, v249, v11
v_add_f32 v250, v250, v12
v_add_f32 v251, v251, v13
v_add_f32 v0, v246, v247
v_add_f32 v0, v0, v248
v_add_f32 v0, v0, v249
v_add_f32 v0, v0, v250
v_add_f32 v0, v0, v251
s_mov_b32 s30, 0x4f800000
v_cmp_nge_f32 vcc, s30, v0
s_lshl_b32 s31, 1, s47
v_rcp_f32 v246, v246
v_rcp_f32 v247, v247
v_rcp_f32 v248, v248
v_rcp_f32 v249, v249
v_rcp_f32 v250, v250
v_rcp_f32 v251, v251
s_cmp_lg_u64 vcc, 0
s_cselect_b32 s31, s31, 0
s_or_b32 s43, s43, s31
v_mbcnt_lo_u32_b32 v0, -1, 0
v_mbcnt_hi_u32_b32 v0, -1, v0
v_and_b32 v2, 15, v0
v_lshrrev_b32 v3, 4, v0
v_lshlrev_b32 v4, 1, v2
v_xor_b32 v4, v4, v3
v_lshlrev_b32 v4, 3, v4
v_lshl_add_u32 v4, v2, 8, v4
v_add_u32 v4, s40, v4
v_xor_b32 v92, 0x0, v4
v_xor_b32 v93, 0x20, v4
v_xor_b32 v94, 0x40, v4
v_xor_b32 v95, 0x60, v4
v_xor_b32 v96, 0x80, v4
v_xor_b32 v97, 0xa0, v4
v_xor_b32 v98, 0xc0, v4
v_xor_b32 v99, 0xe0, v4
v_xor_b32 v4, v2, v3
v_lshlrev_b32 v4, 4, v4
v_lshl_add_u32 v4, v3, 8, v4
v_add_u32 v4, s40, v4
v_xor_b32 v100, 0x0, v4
v_xor_b32 v101, 0x40, v4
v_xor_b32 v102, 0x80, v4
v_xor_b32 v103, 0xc0, v4
ds_read_b128 v[144:147], v104 offset:8192
s_waitcnt lgkmcnt(13)
ds_read_b128 v[148:151], v105 offset:8192
ds_read_b128 v[152:155], v106 offset:8192
s_waitcnt lgkmcnt(13)
ds_read_b128 v[156:159], v107 offset:8192
v_accvgpr_read_b32 v80, a0
v_accvgpr_read_b32 v81, a1
v_accvgpr_read_b32 v82, a2
v_accvgpr_read_b32 v83, a3
v_mul_f32 v80, v80, v246
v_mul_f32 v81, v81, v246
v_mul_f32 v82, v82, v246
v_mul_f32 v83, v83, v246
v_cvt_pk_bf16_f32 v84, v80, v81
v_cvt_pk_bf16_f32 v85, v82, v83
v_accvgpr_read_b32 v86, a4
v_accvgpr_read_b32 v87, a5
v_accvgpr_read_b32 v88, a6
v_accvgpr_read_b32 v89, a7
v_mul_f32 v86, v86, v246
v_mul_f32 v87, v87, v246
v_mul_f32 v88, v88, v246
v_mul_f32 v89, v89, v246
v_cvt_pk_bf16_f32 v90, v86, v87
v_cvt_pk_bf16_f32 v91, v88, v89
ds_write_b64 v92, v[84:85] offset:0
s_waitcnt lgkmcnt(13)
ds_write_b64 v93, v[90:91] offset:0
v_accvgpr_read_b32 v80, a8
v_accvgpr_read_b32 v81, a9
v_accvgpr_read_b32 v82, a10
v_accvgpr_read_b32 v83, a11
v_mul_f32 v80, v80, v246
v_mul_f32 v81, v81, v246
v_mul_f32 v82, v82, v246
v_mul_f32 v83, v83, v246
v_cvt_pk_bf16_f32 v84, v80, v81
v_cvt_pk_bf16_f32 v85, v82, v83
v_accvgpr_read_b32 v86, a12
v_accvgpr_read_b32 v87, a13
v_accvgpr_read_b32 v88, a14
v_accvgpr_read_b32 v89, a15
v_mul_f32 v86, v86, v246
v_mul_f32 v87, v87, v246
v_mul_f32 v88, v88, v246
v_mul_f32 v89, v89, v246
v_cvt_pk_bf16_f32 v90, v86, v87
v_cvt_pk_bf16_f32 v91, v88, v89
ds_write_b64 v94, v[84:85] offset:0
s_waitcnt lgkmcnt(13)
ds_write_b64 v95, v[90:91] offset:0
v_accvgpr_read_b32 v80, a16
v_accvgpr_read_b32 v81, a17
v_accvgpr_read_b32 v82, a18
v_accvgpr_read_b32 v83, a19
v_mul_f32 v80, v80, v246
v_mul_f32 v81, v81, v246
v_mul_f32 v82, v82, v246
v_mul_f32 v83, v83, v246
v_cvt_pk_bf16_f32 v84, v80, v81
v_cvt_pk_bf16_f32 v85, v82, v83
v_accvgpr_read_b32 v86, a20
v_accvgpr_read_b32 v87, a21
v_accvgpr_read_b32 v88, a22
v_accvgpr_read_b32 v89, a23
v_mul_f32 v86, v86, v246
v_mul_f32 v87, v87, v246
v_mul_f32 v88, v88, v246
v_mul_f32 v89, v89, v246
v_cvt_pk_bf16_f32 v90, v86, v87
v_cvt_pk_bf16_f32 v91, v88, v89
ds_write_b64 v96, v[84:85] offset:0
s_waitcnt lgkmcnt(13)
ds_write_b64 v97, v[90:91] offset:0
v_accvgpr_read_b32 v80, a24
v_accvgpr_read_b32 v81, a25
v_accvgpr_read_b32 v82, a26
v_accvgpr_read_b32 v83, a27
v_mul_f32 v80, v80, v246
v_mul_f32 v81, v81, v246
v_mul_f32 v82, v82, v246
v_mul_f32 v83, v83, v246
v_cvt_pk_bf16_f32 v84, v80, v81
v_cvt_pk_bf16_f32 v85, v82, v83
v_accvgpr_read_b32 v86, a28
v_accvgpr_read_b32 v87, a29
v_accvgpr_read_b32 v88, a30
v_accvgpr_read_b32 v89, a31
v_mul_f32 v86, v86, v246
v_mul_f32 v87, v87, v246
v_mul_f32 v88, v88, v246
v_mul_f32 v89, v89, v246
v_cvt_pk_bf16_f32 v90, v86, v87
v_cvt_pk_bf16_f32 v91, v88, v89
ds_write_b64 v98, v[84:85] offset:0
s_waitcnt lgkmcnt(13)
ds_write_b64 v99, v[90:91] offset:0
s_waitcnt lgkmcnt(0)
s_barrier
s_add_u32 m0, s22, 0x0
v_lshlrev_b32 v4, 16, v112
v_and_b32 v5, 0xffff0000, v112
buffer_load_dwordx4 v244, s[4:7], s20 offen nt lds
v_mul_f32 v4, s24, v4
v_mul_f32 v5, s24, v5
v_cvt_pk_bf16_f32 v112, v4, v5
v_lshlrev_b32 v6, 16, v113
v_and_b32 v7, 0xffff0000, v113
v_mul_f32 v6, s24, v6
v_mul_f32 v7, s24, v7
v_cvt_pk_bf16_f32 v113, v6, v7
v_lshlrev_b32 v8, 16, v114
v_and_b32 v9, 0xffff0000, v114
v_mul_f32 v8, s24, v8
v_mul_f32 v9, s24, v9
v_cvt_pk_bf16_f32 v114, v8, v9
v_lshlrev_b32 v10, 16, v115
v_and_b32 v11, 0xffff0000, v115
v_mul_f32 v10, s24, v10
buffer_load_dwordx4 v244, s[4:7], s20 offen offset:2048 nt lds
s_add_u32 s20, s20, 0x2000
v_mul_f32 v11, s24, v11
v_cvt_pk_bf16_f32 v115, v10, v11
v_lshlrev_b32 v4, 16, v116
v_and_b32 v5, 0xffff0000, v116
v_mul_f32 v4, s24, v4
v_mul_f32 v5, s24, v5
v_cvt_pk_bf16_f32 v116, v4, v5
v_lshlrev_b32 v6, 16, v117
v_and_b32 v7, 0xffff0000, v117
v_mul_f32 v6, s24, v6
v_mul_f32 v7, s24, v7
v_cvt_pk_bf16_f32 v117, v6, v7
v_lshlrev_b32 v8, 16, v118
v_and_b32 v9, 0xffff0000, v118
s_add_u32 m0, s22, 0xc000
v_mul_f32 v8, s24, v8
v_mul_f32 v9, s24, v9
buffer_load_dwordx4 v244, s[8:11], s21 offen nt lds
v_cvt_pk_bf16_f32 v118, v8, v9
v_lshlrev_b32 v10, 16, v119
v_and_b32 v11, 0xffff0000, v119
v_mul_f32 v10, s24, v10
v_mul_f32 v11, s24, v11
v_cvt_pk_bf16_f32 v119, v10, v11
v_lshlrev_b32 v4, 16, v120
v_and_b32 v5, 0xffff0000, v120
v_mul_f32 v4, s24, v4
v_mul_f32 v5, s24, v5
v_cvt_pk_bf16_f32 v120, v4, v5
v_lshlrev_b32 v6, 16, v121
v_and_b32 v7, 0xffff0000, v121
v_mul_f32 v6, s24, v6
v_mul_f32 v7, s24, v7
v_cvt_pk_bf16_f32 v121, v6, v7
buffer_load_dwordx4 v244, s[8:11], s21 offen offset:2048 nt lds
s_add_u32 s21, s21, 0x2000
v_lshlrev_b32 v8, 16, v122
v_and_b32 v9, 0xffff0000, v122
v_mul_f32 v8, s24, v8
v_mul_f32 v9, s24, v9
v_cvt_pk_bf16_f32 v122, v8, v9
v_lshlrev_b32 v10, 16, v123
v_and_b32 v11, 0xffff0000, v123
v_mul_f32 v10, s24, v10
v_mul_f32 v11, s24, v11
v_cvt_pk_bf16_f32 v123, v10, v11
v_lshlrev_b32 v4, 16, v124
v_and_b32 v5, 0xffff0000, v124
v_mul_f32 v4, s24, v4
v_mul_f32 v5, s24, v5
v_cvt_pk_bf16_f32 v124, v4, v5
v_lshlrev_b32 v6, 16, v125
buffer_load_dword v255, v244, s[12:15], s42 offen
v_and_b32 v7, 0xffff0000, v125
v_mul_f32 v6, s24, v6
v_mul_f32 v7, s24, v7
v_cvt_pk_bf16_f32 v125, v6, v7
v_lshlrev_b32 v8, 16, v126
v_and_b32 v9, 0xffff0000, v126
v_mul_f32 v8, s24, v8
v_mul_f32 v9, s24, v9
v_cvt_pk_bf16_f32 v126, v8, v9
v_lshlrev_b32 v10, 16, v127
v_and_b32 v11, 0xffff0000, v127
v_mul_f32 v10, s24, v10
v_mul_f32 v11, s24, v11
v_cvt_pk_bf16_f32 v127, v10, v11
ds_read_b128 v[160:163], v104 offset:12288
ds_read_b128 v[164:167], v105 offset:12288
ds_read_b128 v[168:171], v106 offset:12288
ds_read_b128 v[172:175], v107 offset:12288
v_accvgpr_read_b32 v80, a32
v_accvgpr_read_b32 v81, a33
v_accvgpr_read_b32 v82, a34
v_accvgpr_read_b32 v83, a35
v_mfma_f32_16x16x32_bf16 v[16:19], a[192:195], v[112:115], 0
v_mul_f32 v80, v80, v247
v_mul_f32 v81, v81, v247
v_mul_f32 v82, v82, v247
v_mul_f32 v83, v83, v247
v_cvt_pk_bf16_f32 v84, v80, v81
v_cvt_pk_bf16_f32 v85, v82, v83
v_accvgpr_read_b32 v86, a36
v_accvgpr_read_b32 v87, a37
v_accvgpr_read_b32 v88, a38
v_accvgpr_read_b32 v89, a39
v_mul_f32 v86, v86, v247
v_mul_f32 v87, v87, v247
v_mul_f32 v88, v88, v247
v_mul_f32 v89, v89, v247
v_cvt_pk_bf16_f32 v90, v86, v87
v_cvt_pk_bf16_f32 v91, v88, v89
v_mfma_f32_16x16x32_bf16 v[16:19], a[196:199], v[116:119], v[16:19]
ds_write_b64 v92, v[84:85] offset:4096
ds_write_b64 v93, v[90:91] offset:4096
v_accvgpr_read_b32 v80, a40
v_accvgpr_read_b32 v81, a41
v_accvgpr_read_b32 v82, a42
v_accvgpr_read_b32 v83, a43
v_mfma_f32_16x16x32_bf16 v[16:19], a[200:203], v[120:123], v[16:19]
v_mul_f32 v80, v80, v247
v_mul_f32 v81, v81, v247
v_mul_f32 v82, v82, v247
v_mul_f32 v83, v83, v247
v_cvt_pk_bf16_f32 v84, v80, v81
v_cvt_pk_bf16_f32 v85, v82, v83
v_accvgpr_read_b32 v86, a44
v_accvgpr_read_b32 v87, a45
v_accvgpr_read_b32 v88, a46
v_accvgpr_read_b32 v89, a47
v_mul_f32 v86, v86, v247
v_mul_f32 v87, v87, v247
v_mul_f32 v88, v88, v247
v_mul_f32 v89, v89, v247
v_cvt_pk_bf16_f32 v90, v86, v87
v_cvt_pk_bf16_f32 v91, v88, v89
v_mfma_f32_16x16x32_bf16 v[16:19], a[204:207], v[124:127], v[16:19]
ds_write_b64 v94, v[84:85] offset:4096
ds_write_b64 v95, v[90:91] offset:4096
v_accvgpr_read_b32 v80, a48
v_accvgpr_read_b32 v81, a49
v_accvgpr_read_b32 v82, a50
v_accvgpr_read_b32 v83, a51
v_mfma_f32_16x16x32_bf16 v[20:23], a[208:211], v[112:115], 0
v_mul_f32 v80, v80, v247
v_mul_f32 v81, v81, v247
v_mul_f32 v82, v82, v247
v_mul_f32 v83, v83, v247
v_cvt_pk_bf16_f32 v84, v80, v81
v_cvt_pk_bf16_f32 v85, v82, v83
v_accvgpr_read_b32 v86, a52
v_accvgpr_read_b32 v87, a53
v_accvgpr_read_b32 v88, a54
v_accvgpr_read_b32 v89, a55
v_mul_f32 v86, v86, v247
v_mul_f32 v87, v87, v247
v_mul_f32 v88, v88, v247
v_mul_f32 v89, v89, v247
v_cvt_pk_bf16_f32 v90, v86, v87
v_cvt_pk_bf16_f32 v91, v88, v89
v_mfma_f32_16x16x32_bf16 v[20:23], a[212:215], v[116:119], v[20:23]
ds_write_b64 v96, v[84:85] offset:4096
ds_write_b64 v97, v[90:91] offset:4096
v_accvgpr_read_b32 v80, a56
v_accvgpr_read_b32 v81, a57
v_accvgpr_read_b32 v82, a58
v_accvgpr_read_b32 v83, a59
v_mfma_f32_16x16x32_bf16 v[20:23], a[216:219], v[120:123], v[20:23]
v_mul_f32 v80, v80, v247
v_mul_f32 v81, v81, v247
v_mul_f32 v82, v82, v247
v_mul_f32 v83, v83, v247
v_cvt_pk_bf16_f32 v84, v80, v81
v_cvt_pk_bf16_f32 v85, v82, v83
v_accvgpr_read_b32 v86, a60
v_accvgpr_read_b32 v87, a61
v_accvgpr_read_b32 v88, a62
v_accvgpr_read_b32 v89, a63
v_mul_f32 v86, v86, v247
v_mul_f32 v87, v87, v247
v_mul_f32 v88, v88, v247
v_mul_f32 v89, v89, v247
v_cvt_pk_bf16_f32 v90, v86, v87
v_cvt_pk_bf16_f32 v91, v88, v89
v_mfma_f32_16x16x32_bf16 v[20:23], a[220:223], v[124:127], v[20:23]
ds_write_b64 v98, v[84:85] offset:4096
ds_write_b64 v99, v[90:91] offset:4096
v_lshlrev_b32 v4, 16, v128
v_and_b32 v5, 0xffff0000, v128
v_mul_f32 v4, s24, v4
v_mul_f32 v5, s24, v5
v_cvt_pk_bf16_f32 v128, v4, v5
v_lshlrev_b32 v6, 16, v129
v_and_b32 v7, 0xffff0000, v129
v_mul_f32 v6, s24, v6
v_mul_f32 v7, s24, v7
v_max3_f32 v0, v16, v17, v18
v_cvt_pk_bf16_f32 v129, v6, v7
v_max3_f32 v0, v0, v19, v20
v_lshlrev_b32 v8, 16, v130
v_max3_f32 v0, v0, v21, v22
v_and_b32 v9, 0xffff0000, v130
v_max_f32 v0, v0, v23
v_mul_f32 v8, s24, v8
v_mov_b32 v1, v0
v_mul_f32 v9, s24, v9
s_nop 0
v_permlane16_swap_b32 v0, v1
v_cvt_pk_bf16_f32 v130, v8, v9
v_max_f32 v0, v0, v1
v_lshlrev_b32 v10, 16, v131
v_mov_b32 v1, v0
v_and_b32 v11, 0xffff0000, v131
s_nop 0
v_permlane32_swap_b32 v0, v1
v_mul_f32 v10, s24, v10
v_max_f32 v0, v0, v1
v_mul_f32 v11, s24, v11
v_sub_f32 v0, 0, v0
v_cvt_pk_bf16_f32 v131, v10, v11
v_cndmask_b32 v0, v0, v208, s[50:51]
v_lshlrev_b32 v4, 16, v132
v_mov_b32 v208, v0
v_and_b32 v5, 0xffff0000, v132
v_mov_b32 v209, v0
v_mul_f32 v4, s24, v4
v_mov_b32 v210, v0
v_mul_f32 v5, s24, v5
v_mov_b32 v211, v0
v_cvt_pk_bf16_f32 v132, v4, v5
v_add_f32 v16, v16, v0
v_lshlrev_b32 v6, 16, v133
v_add_f32 v17, v17, v0
v_and_b32 v7, 0xffff0000, v133
v_add_f32 v18, v18, v0
v_mul_f32 v6, s24, v6
v_add_f32 v19, v19, v0
v_mul_f32 v7, s24, v7
v_add_f32 v20, v20, v0
v_cvt_pk_bf16_f32 v133, v6, v7
v_add_f32 v21, v21, v0
v_lshlrev_b32 v8, 16, v134
v_add_f32 v22, v22, v0
v_and_b32 v9, 0xffff0000, v134
v_add_f32 v23, v23, v0
v_mul_f32 v8, s24, v8
v_mov_b32 v246, 0
v_mul_f32 v9, s24, v9
v_exp_f32 v16, v16
v_cvt_pk_bf16_f32 v134, v8, v9
v_exp_f32 v17, v17
v_lshlrev_b32 v10, 16, v135
v_exp_f32 v18, v18
v_and_b32 v11, 0xffff0000, v135
v_add_f32 v246, v246, v16
v_mul_f32 v10, s24, v10
v_exp_f32 v19, v19
v_mul_f32 v11, s24, v11
v_add_f32 v246, v246, v17
v_cvt_pk_bf16_f32 v135, v10, v11
v_cvt_pk_bf16_f32 v16, v16, v17
v_lshlrev_b32 v4, 16, v136
v_exp_f32 v20, v20
v_and_b32 v5, 0xffff0000, v136
v_add_f32 v246, v246, v18
v_mul_f32 v4, s24, v4
v_exp_f32 v21, v21
v_mul_f32 v5, s24, v5
v_add_f32 v246, v246, v19
v_cvt_pk_bf16_f32 v136, v4, v5
v_cvt_pk_bf16_f32 v17, v18, v19
v_lshlrev_b32 v6, 16, v137
v_exp_f32 v22, v22
v_and_b32 v7, 0xffff0000, v137
v_add_f32 v246, v246, v20
v_mul_f32 v6, s24, v6
v_exp_f32 v23, v23
v_mul_f32 v7, s24, v7
v_add_f32 v246, v246, v21
v_cvt_pk_bf16_f32 v137, v6, v7
v_cvt_pk_bf16_f32 v18, v20, v21
v_lshlrev_b32 v8, 16, v138
v_add_f32 v246, v246, v22
v_and_b32 v9, 0xffff0000, v138
v_add_f32 v246, v246, v23
v_mul_f32 v8, s24, v8
v_cvt_pk_bf16_f32 v19, v22, v23
v_mul_f32 v9, s24, v9
v_cvt_pk_bf16_f32 v138, v8, v9
v_lshlrev_b32 v10, 16, v139
v_and_b32 v11, 0xffff0000, v139
v_mul_f32 v10, s24, v10
v_mul_f32 v11, s24, v11
v_cvt_pk_bf16_f32 v139, v10, v11
v_lshlrev_b32 v4, 16, v140
v_and_b32 v5, 0xffff0000, v140
v_mul_f32 v4, s24, v4
v_mul_f32 v5, s24, v5
v_cvt_pk_bf16_f32 v140, v4, v5
v_lshlrev_b32 v6, 16, v141
v_and_b32 v7, 0xffff0000, v141
v_mul_f32 v6, s24, v6
v_mul_f32 v7, s24, v7
v_cvt_pk_bf16_f32 v141, v6, v7
v_lshlrev_b32 v8, 16, v142
v_and_b32 v9, 0xffff0000, v142
v_mul_f32 v8, s24, v8
v_mul_f32 v9, s24, v9
v_cvt_pk_bf16_f32 v142, v8, v9
v_lshlrev_b32 v10, 16, v143
v_and_b32 v11, 0xffff0000, v143
v_mul_f32 v10, s24, v10
v_mul_f32 v11, s24, v11
v_cvt_pk_bf16_f32 v143, v10, v11
ds_read_b128 v[176:179], v104 offset:16384
ds_read_b128 v[180:183], v105 offset:16384
ds_read_b128 v[184:187], v106 offset:16384
s_waitcnt lgkmcnt(13)
ds_read_b128 v[188:191], v107 offset:16384
v_accvgpr_read_b32 v80, a64
v_accvgpr_read_b32 v81, a65
v_accvgpr_read_b32 v82, a66
v_accvgpr_read_b32 v83, a67
v_mfma_f32_16x16x32_bf16 v[24:27], a[192:195], v[128:131], 0
v_mul_f32 v80, v80, v248
v_mul_f32 v81, v81, v248
v_mul_f32 v82, v82, v248
v_mul_f32 v83, v83, v248
v_cvt_pk_bf16_f32 v84, v80, v81
v_cvt_pk_bf16_f32 v85, v82, v83
v_accvgpr_read_b32 v86, a68
v_accvgpr_read_b32 v87, a69
v_accvgpr_read_b32 v88, a70
v_accvgpr_read_b32 v89, a71
v_mul_f32 v86, v86, v248
v_mul_f32 v87, v87, v248
v_mul_f32 v88, v88, v248
v_mul_f32 v89, v89, v248
v_cvt_pk_bf16_f32 v90, v86, v87
v_cvt_pk_bf16_f32 v91, v88, v89
v_mfma_f32_16x16x32_bf16 v[24:27], a[196:199], v[132:135], v[24:27]
ds_write_b64 v92, v[84:85] offset:8192
s_waitcnt lgkmcnt(13)
ds_write_b64 v93, v[90:91] offset:8192
v_accvgpr_read_b32 v80, a72
v_accvgpr_read_b32 v81, a73
v_accvgpr_read_b32 v82, a74
v_accvgpr_read_b32 v83, a75
v_mfma_f32_16x16x32_bf16 v[24:27], a[200:203], v[136:139], v[24:27]
v_mul_f32 v80, v80, v248
v_mul_f32 v81, v81, v248
v_mul_f32 v82, v82, v248
v_mul_f32 v83, v83, v248
v_cvt_pk_bf16_f32 v84, v80, v81
v_cvt_pk_bf16_f32 v85, v82, v83
v_accvgpr_read_b32 v86, a76
v_accvgpr_read_b32 v87, a77
v_accvgpr_read_b32 v88, a78
v_accvgpr_read_b32 v89, a79
v_mul_f32 v86, v86, v248
v_mul_f32 v87, v87, v248
v_mul_f32 v88, v88, v248
v_mul_f32 v89, v89, v248
v_cvt_pk_bf16_f32 v90, v86, v87
v_cvt_pk_bf16_f32 v91, v88, v89
v_mfma_f32_16x16x32_bf16 v[24:27], a[204:207], v[140:143], v[24:27]
ds_write_b64 v94, v[84:85] offset:8192
s_waitcnt lgkmcnt(13)
ds_write_b64 v95, v[90:91] offset:8192
v_accvgpr_read_b32 v80, a80
v_accvgpr_read_b32 v81, a81
v_accvgpr_read_b32 v82, a82
v_accvgpr_read_b32 v83, a83
v_mfma_f32_16x16x32_bf16 v[28:31], a[208:211], v[128:131], 0
v_mul_f32 v80, v80, v248
v_mul_f32 v81, v81, v248
v_mul_f32 v82, v82, v248
v_mul_f32 v83, v83, v248
v_cvt_pk_bf16_f32 v84, v80, v81
v_cvt_pk_bf16_f32 v85, v82, v83
v_accvgpr_read_b32 v86, a84
v_accvgpr_read_b32 v87, a85
v_accvgpr_read_b32 v88, a86
v_accvgpr_read_b32 v89, a87
v_mul_f32 v86, v86, v248
v_mul_f32 v87, v87, v248
v_mul_f32 v88, v88, v248
v_mul_f32 v89, v89, v248
v_cvt_pk_bf16_f32 v90, v86, v87
v_cvt_pk_bf16_f32 v91, v88, v89
v_mfma_f32_16x16x32_bf16 v[28:31], a[212:215], v[132:135], v[28:31]
ds_write_b64 v96, v[84:85] offset:8192
s_waitcnt lgkmcnt(13)
ds_write_b64 v97, v[90:91] offset:8192
v_accvgpr_read_b32 v80, a88
v_accvgpr_read_b32 v81, a89
v_accvgpr_read_b32 v82, a90
v_accvgpr_read_b32 v83, a91
v_mfma_f32_16x16x32_bf16 v[28:31], a[216:219], v[136:139], v[28:31]
v_mul_f32 v80, v80, v248
v_mul_f32 v81, v81, v248
v_mul_f32 v82, v82, v248
v_mul_f32 v83, v83, v248
v_cvt_pk_bf16_f32 v84, v80, v81
v_cvt_pk_bf16_f32 v85, v82, v83
v_accvgpr_read_b32 v86, a92
v_accvgpr_read_b32 v87, a93
v_accvgpr_read_b32 v88, a94
v_accvgpr_read_b32 v89, a95
v_mul_f32 v86, v86, v248
v_mul_f32 v87, v87, v248
v_mul_f32 v88, v88, v248
v_mul_f32 v89, v89, v248
v_cvt_pk_bf16_f32 v90, v86, v87
v_cvt_pk_bf16_f32 v91, v88, v89
v_mfma_f32_16x16x32_bf16 v[28:31], a[220:223], v[140:143], v[28:31]
ds_write_b64 v98, v[84:85] offset:8192
s_waitcnt lgkmcnt(13)
ds_write_b64 v99, v[90:91] offset:8192
v_lshlrev_b32 v4, 16, v144
v_and_b32 v5, 0xffff0000, v144
v_mul_f32 v4, s24, v4
v_mul_f32 v5, s24, v5
v_cvt_pk_bf16_f32 v144, v4, v5
v_lshlrev_b32 v6, 16, v145
v_and_b32 v7, 0xffff0000, v145
v_mul_f32 v6, s24, v6
v_mul_f32 v7, s24, v7
v_max3_f32 v0, v24, v25, v26
v_cvt_pk_bf16_f32 v145, v6, v7
v_max3_f32 v0, v0, v27, v28
v_lshlrev_b32 v8, 16, v146
v_max3_f32 v0, v0, v29, v30
v_and_b32 v9, 0xffff0000, v146
v_max_f32 v0, v0, v31
v_mul_f32 v8, s24, v8
v_mov_b32 v1, v0
v_mul_f32 v9, s24, v9
s_nop 0
v_permlane16_swap_b32 v0, v1
v_cvt_pk_bf16_f32 v146, v8, v9
v_max_f32 v0, v0, v1
v_lshlrev_b32 v10, 16, v147
v_mov_b32 v1, v0
v_and_b32 v11, 0xffff0000, v147
s_nop 0
v_permlane32_swap_b32 v0, v1
v_mul_f32 v10, s24, v10
v_max_f32 v0, v0, v1
v_mul_f32 v11, s24, v11
v_sub_f32 v0, 0, v0
v_cvt_pk_bf16_f32 v147, v10, v11
v_cndmask_b32 v0, v0, v212, s[50:51]
v_lshlrev_b32 v4, 16, v148
v_mov_b32 v212, v0
v_and_b32 v5, 0xffff0000, v148
v_mov_b32 v213, v0
v_mul_f32 v4, s24, v4
v_mov_b32 v214, v0
v_mul_f32 v5, s24, v5
v_mov_b32 v215, v0
v_cvt_pk_bf16_f32 v148, v4, v5
v_add_f32 v24, v24, v0
v_lshlrev_b32 v6, 16, v149
v_add_f32 v25, v25, v0
v_and_b32 v7, 0xffff0000, v149
v_add_f32 v26, v26, v0
v_mul_f32 v6, s24, v6
v_add_f32 v27, v27, v0
v_mul_f32 v7, s24, v7
v_add_f32 v28, v28, v0
v_cvt_pk_bf16_f32 v149, v6, v7
v_add_f32 v29, v29, v0
v_lshlrev_b32 v8, 16, v150
v_add_f32 v30, v30, v0
v_and_b32 v9, 0xffff0000, v150
v_add_f32 v31, v31, v0
v_mul_f32 v8, s24, v8
v_mov_b32 v247, 0
v_mul_f32 v9, s24, v9
v_exp_f32 v24, v24
v_cvt_pk_bf16_f32 v150, v8, v9
v_exp_f32 v25, v25
v_lshlrev_b32 v10, 16, v151
v_exp_f32 v26, v26
v_and_b32 v11, 0xffff0000, v151
v_add_f32 v247, v247, v24
v_mul_f32 v10, s24, v10
v_exp_f32 v27, v27
v_mul_f32 v11, s24, v11
v_add_f32 v247, v247, v25
v_cvt_pk_bf16_f32 v151, v10, v11
v_cvt_pk_bf16_f32 v24, v24, v25
v_lshlrev_b32 v4, 16, v152
v_exp_f32 v28, v28
v_and_b32 v5, 0xffff0000, v152
v_add_f32 v247, v247, v26
v_mul_f32 v4, s24, v4
v_exp_f32 v29, v29
v_mul_f32 v5, s24, v5
v_add_f32 v247, v247, v27
v_cvt_pk_bf16_f32 v152, v4, v5
v_cvt_pk_bf16_f32 v25, v26, v27
v_lshlrev_b32 v6, 16, v153
v_exp_f32 v30, v30
v_and_b32 v7, 0xffff0000, v153
v_add_f32 v247, v247, v28
v_mul_f32 v6, s24, v6
v_exp_f32 v31, v31
v_mul_f32 v7, s24, v7
v_add_f32 v247, v247, v29
v_cvt_pk_bf16_f32 v153, v6, v7
v_cvt_pk_bf16_f32 v26, v28, v29
v_lshlrev_b32 v8, 16, v154
v_add_f32 v247, v247, v30
v_and_b32 v9, 0xffff0000, v154
v_add_f32 v247, v247, v31
v_mul_f32 v8, s24, v8
v_cvt_pk_bf16_f32 v27, v30, v31
v_mul_f32 v9, s24, v9
v_cvt_pk_bf16_f32 v154, v8, v9
v_lshlrev_b32 v10, 16, v155
v_and_b32 v11, 0xffff0000, v155
v_mul_f32 v10, s24, v10
v_mul_f32 v11, s24, v11
v_cvt_pk_bf16_f32 v155, v10, v11
v_lshlrev_b32 v4, 16, v156
v_and_b32 v5, 0xffff0000, v156
v_mul_f32 v4, s24, v4
v_mul_f32 v5, s24, v5
v_cvt_pk_bf16_f32 v156, v4, v5
v_lshlrev_b32 v6, 16, v157
v_and_b32 v7, 0xffff0000, v157
v_mul_f32 v6, s24, v6
v_mul_f32 v7, s24, v7
v_cvt_pk_bf16_f32 v157, v6, v7
v_lshlrev_b32 v8, 16, v158
v_and_b32 v9, 0xffff0000, v158
v_mul_f32 v8, s24, v8
v_mul_f32 v9, s24, v9
v_cvt_pk_bf16_f32 v158, v8, v9
v_lshlrev_b32 v10, 16, v159
v_and_b32 v11, 0xffff0000, v159
v_mul_f32 v10, s24, v10
v_mul_f32 v11, s24, v11
v_cvt_pk_bf16_f32 v159, v10, v11
ds_read_b128 v[192:195], v104 offset:20480
s_waitcnt lgkmcnt(13)
ds_read_b128 v[196:199], v105 offset:20480
ds_read_b128 v[200:203], v106 offset:20480
s_waitcnt lgkmcnt(13)
ds_read_b128 v[204:207], v107 offset:20480
v_accvgpr_read_b32 v80, a96
v_accvgpr_read_b32 v81, a97
v_accvgpr_read_b32 v82, a98
v_accvgpr_read_b32 v83, a99
v_mfma_f32_16x16x32_bf16 v[32:35], a[192:195], v[144:147], 0
v_mul_f32 v80, v80, v249
v_mul_f32 v81, v81, v249
v_mul_f32 v82, v82, v249
v_mul_f32 v83, v83, v249
v_cvt_pk_bf16_f32 v84, v80, v81
v_cvt_pk_bf16_f32 v85, v82, v83
v_accvgpr_read_b32 v86, a100
v_accvgpr_read_b32 v87, a101
v_accvgpr_read_b32 v88, a102
v_accvgpr_read_b32 v89, a103
v_mul_f32 v86, v86, v249
v_mul_f32 v87, v87, v249
v_mul_f32 v88, v88, v249
v_mul_f32 v89, v89, v249
v_cvt_pk_bf16_f32 v90, v86, v87
v_cvt_pk_bf16_f32 v91, v88, v89
v_mfma_f32_16x16x32_bf16 v[32:35], a[196:199], v[148:151], v[32:35]
ds_write_b64 v92, v[84:85] offset:12288
s_waitcnt lgkmcnt(13)
ds_write_b64 v93, v[90:91] offset:12288
v_accvgpr_read_b32 v80, a104
v_accvgpr_read_b32 v81, a105
v_accvgpr_read_b32 v82, a106
v_accvgpr_read_b32 v83, a107
v_mfma_f32_16x16x32_bf16 v[32:35], a[200:203], v[152:155], v[32:35]
v_mul_f32 v80, v80, v249
v_mul_f32 v81, v81, v249
v_mul_f32 v82, v82, v249
v_mul_f32 v83, v83, v249
v_cvt_pk_bf16_f32 v84, v80, v81
v_cvt_pk_bf16_f32 v85, v82, v83
v_accvgpr_read_b32 v86, a108
v_accvgpr_read_b32 v87, a109
v_accvgpr_read_b32 v88, a110
v_accvgpr_read_b32 v89, a111
v_mul_f32 v86, v86, v249
v_mul_f32 v87, v87, v249
v_mul_f32 v88, v88, v249
v_mul_f32 v89, v89, v249
v_cvt_pk_bf16_f32 v90, v86, v87
v_cvt_pk_bf16_f32 v91, v88, v89
v_mfma_f32_16x16x32_bf16 v[32:35], a[204:207], v[156:159], v[32:35]
ds_write_b64 v94, v[84:85] offset:12288
s_waitcnt lgkmcnt(13)
ds_write_b64 v95, v[90:91] offset:12288
v_accvgpr_read_b32 v80, a112
v_accvgpr_read_b32 v81, a113
v_accvgpr_read_b32 v82, a114
v_accvgpr_read_b32 v83, a115
v_mfma_f32_16x16x32_bf16 v[36:39], a[208:211], v[144:147], 0
v_mul_f32 v80, v80, v249
v_mul_f32 v81, v81, v249
v_mul_f32 v82, v82, v249
v_mul_f32 v83, v83, v249
v_cvt_pk_bf16_f32 v84, v80, v81
v_cvt_pk_bf16_f32 v85, v82, v83
v_accvgpr_read_b32 v86, a116
v_accvgpr_read_b32 v87, a117
v_accvgpr_read_b32 v88, a118
v_accvgpr_read_b32 v89, a119
v_mul_f32 v86, v86, v249
v_mul_f32 v87, v87, v249
v_mul_f32 v88, v88, v249
v_mul_f32 v89, v89, v249
v_cvt_pk_bf16_f32 v90, v86, v87
v_cvt_pk_bf16_f32 v91, v88, v89
v_mfma_f32_16x16x32_bf16 v[36:39], a[212:215], v[148:151], v[36:39]
ds_write_b64 v96, v[84:85] offset:12288
s_waitcnt lgkmcnt(13)
ds_write_b64 v97, v[90:91] offset:12288
v_accvgpr_read_b32 v80, a120
v_accvgpr_read_b32 v81, a121
v_accvgpr_read_b32 v82, a122
v_accvgpr_read_b32 v83, a123
v_mfma_f32_16x16x32_bf16 v[36:39], a[216:219], v[152:155], v[36:39]
v_mul_f32 v80, v80, v249
v_mul_f32 v81, v81, v249
v_mul_f32 v82, v82, v249
v_mul_f32 v83, v83, v249
v_cvt_pk_bf16_f32 v84, v80, v81
v_cvt_pk_bf16_f32 v85, v82, v83
v_accvgpr_read_b32 v86, a124
v_accvgpr_read_b32 v87, a125
v_accvgpr_read_b32 v88, a126
v_accvgpr_read_b32 v89, a127
v_mul_f32 v86, v86, v249
v_mul_f32 v87, v87, v249
v_mul_f32 v88, v88, v249
v_mul_f32 v89, v89, v249
v_cvt_pk_bf16_f32 v90, v86, v87
v_cvt_pk_bf16_f32 v91, v88, v89
v_mfma_f32_16x16x32_bf16 v[36:39], a[220:223], v[156:159], v[36:39]
ds_write_b64 v98, v[84:85] offset:12288
s_waitcnt lgkmcnt(13)
ds_write_b64 v99, v[90:91] offset:12288
v_lshlrev_b32 v4, 16, v160
v_and_b32 v5, 0xffff0000, v160
v_mul_f32 v4, s24, v4
v_mul_f32 v5, s24, v5
v_cvt_pk_bf16_f32 v160, v4, v5
v_lshlrev_b32 v6, 16, v161
v_and_b32 v7, 0xffff0000, v161
v_mul_f32 v6, s24, v6
v_mul_f32 v7, s24, v7
v_max3_f32 v0, v32, v33, v34
v_cvt_pk_bf16_f32 v161, v6, v7
v_max3_f32 v0, v0, v35, v36
v_lshlrev_b32 v8, 16, v162
v_max3_f32 v0, v0, v37, v38
v_and_b32 v9, 0xffff0000, v162
v_max_f32 v0, v0, v39
v_mul_f32 v8, s24, v8
v_mov_b32 v1, v0
v_mul_f32 v9, s24, v9
s_nop 0
v_permlane16_swap_b32 v0, v1
v_cvt_pk_bf16_f32 v162, v8, v9
v_max_f32 v0, v0, v1
v_lshlrev_b32 v10, 16, v163
v_mov_b32 v1, v0
v_and_b32 v11, 0xffff0000, v163
s_nop 0
v_permlane32_swap_b32 v0, v1
v_mul_f32 v10, s24, v10
v_max_f32 v0, v0, v1
v_mul_f32 v11, s24, v11
v_sub_f32 v0, 0, v0
v_cvt_pk_bf16_f32 v163, v10, v11
v_cndmask_b32 v0, v0, v216, s[50:51]
v_lshlrev_b32 v4, 16, v164
v_mov_b32 v216, v0
v_and_b32 v5, 0xffff0000, v164
v_mov_b32 v217, v0
v_mul_f32 v4, s24, v4
v_mov_b32 v218, v0
v_mul_f32 v5, s24, v5
v_mov_b32 v219, v0
v_cvt_pk_bf16_f32 v164, v4, v5
v_add_f32 v32, v32, v0
v_lshlrev_b32 v6, 16, v165
v_add_f32 v33, v33, v0
v_and_b32 v7, 0xffff0000, v165
v_add_f32 v34, v34, v0
v_mul_f32 v6, s24, v6
v_add_f32 v35, v35, v0
v_mul_f32 v7, s24, v7
v_add_f32 v36, v36, v0
v_cvt_pk_bf16_f32 v165, v6, v7
v_add_f32 v37, v37, v0
v_lshlrev_b32 v8, 16, v166
v_add_f32 v38, v38, v0
v_and_b32 v9, 0xffff0000, v166
v_add_f32 v39, v39, v0
v_mul_f32 v8, s24, v8
v_mov_b32 v248, 0
v_mul_f32 v9, s24, v9
v_exp_f32 v32, v32
v_cvt_pk_bf16_f32 v166, v8, v9
v_exp_f32 v33, v33
v_lshlrev_b32 v10, 16, v167
v_exp_f32 v34, v34
v_and_b32 v11, 0xffff0000, v167
v_add_f32 v248, v248, v32
v_mul_f32 v10, s24, v10
v_exp_f32 v35, v35
v_mul_f32 v11, s24, v11
v_add_f32 v248, v248, v33
v_cvt_pk_bf16_f32 v167, v10, v11
v_cvt_pk_bf16_f32 v32, v32, v33
v_lshlrev_b32 v4, 16, v168
v_exp_f32 v36, v36
v_and_b32 v5, 0xffff0000, v168
v_add_f32 v248, v248, v34
v_mul_f32 v4, s24, v4
v_exp_f32 v37, v37
v_mul_f32 v5, s24, v5
v_add_f32 v248, v248, v35
v_cvt_pk_bf16_f32 v168, v4, v5
v_cvt_pk_bf16_f32 v33, v34, v35
v_lshlrev_b32 v6, 16, v169
v_exp_f32 v38, v38
v_and_b32 v7, 0xffff0000, v169
v_add_f32 v248, v248, v36
v_mul_f32 v6, s24, v6
v_exp_f32 v39, v39
v_mul_f32 v7, s24, v7
v_add_f32 v248, v248, v37
v_cvt_pk_bf16_f32 v169, v6, v7
v_cvt_pk_bf16_f32 v34, v36, v37
v_lshlrev_b32 v8, 16, v170
v_add_f32 v248, v248, v38
v_and_b32 v9, 0xffff0000, v170
v_add_f32 v248, v248, v39
v_mul_f32 v8, s24, v8
v_cvt_pk_bf16_f32 v35, v38, v39
v_mul_f32 v9, s24, v9
v_cvt_pk_bf16_f32 v170, v8, v9
v_lshlrev_b32 v10, 16, v171
v_and_b32 v11, 0xffff0000, v171
v_mul_f32 v10, s24, v10
v_mul_f32 v11, s24, v11
v_cvt_pk_bf16_f32 v171, v10, v11
v_lshlrev_b32 v4, 16, v172
v_and_b32 v5, 0xffff0000, v172
v_mul_f32 v4, s24, v4
v_mul_f32 v5, s24, v5
v_cvt_pk_bf16_f32 v172, v4, v5
v_lshlrev_b32 v6, 16, v173
v_and_b32 v7, 0xffff0000, v173
v_mul_f32 v6, s24, v6
v_mul_f32 v7, s24, v7
v_cvt_pk_bf16_f32 v173, v6, v7
v_lshlrev_b32 v8, 16, v174
v_and_b32 v9, 0xffff0000, v174
v_mul_f32 v8, s24, v8
v_mul_f32 v9, s24, v9
v_cvt_pk_bf16_f32 v174, v8, v9
v_lshlrev_b32 v10, 16, v175
v_and_b32 v11, 0xffff0000, v175
v_mul_f32 v10, s24, v10
v_mul_f32 v11, s24, v11
v_cvt_pk_bf16_f32 v175, v10, v11
ds_read_b128 a[224:227], v232 offset:8192
s_waitcnt lgkmcnt(13)
ds_read_b128 a[228:231], v233 offset:8192
ds_read_b128 a[232:235], v234 offset:8192
s_waitcnt lgkmcnt(13)
ds_read_b128 a[236:239], v235 offset:8192
ds_read_b128 a[240:243], v232 offset:12288
s_waitcnt lgkmcnt(13)
ds_read_b128 a[244:247], v233 offset:12288
ds_read_b128 a[248:251], v234 offset:12288
s_waitcnt lgkmcnt(13)
ds_read_b128 a[252:255], v235 offset:12288
v_accvgpr_read_b32 v80, a128
v_accvgpr_read_b32 v81, a129
v_accvgpr_read_b32 v82, a130
v_accvgpr_read_b32 v83, a131
v_mfma_f32_16x16x32_bf16 v[40:43], a[192:195], v[160:163], 0
v_mul_f32 v80, v80, v250
v_mul_f32 v81, v81, v250
v_mul_f32 v82, v82, v250
v_mul_f32 v83, v83, v250
v_cvt_pk_bf16_f32 v84, v80, v81
v_cvt_pk_bf16_f32 v85, v82, v83
v_accvgpr_read_b32 v86, a132
v_accvgpr_read_b32 v87, a133
v_accvgpr_read_b32 v88, a134
v_accvgpr_read_b32 v89, a135
v_mul_f32 v86, v86, v250
v_mul_f32 v87, v87, v250
v_mul_f32 v88, v88, v250
v_mul_f32 v89, v89, v250
v_cvt_pk_bf16_f32 v90, v86, v87
v_cvt_pk_bf16_f32 v91, v88, v89
v_mfma_f32_16x16x32_bf16 v[40:43], a[196:199], v[164:167], v[40:43]
ds_write_b64 v92, v[84:85] offset:16384
s_waitcnt lgkmcnt(13)
ds_write_b64 v93, v[90:91] offset:16384
v_accvgpr_read_b32 v80, a136
v_accvgpr_read_b32 v81, a137
v_accvgpr_read_b32 v82, a138
v_accvgpr_read_b32 v83, a139
v_mfma_f32_16x16x32_bf16 v[40:43], a[200:203], v[168:171], v[40:43]
v_mul_f32 v80, v80, v250
v_mul_f32 v81, v81, v250
v_mul_f32 v82, v82, v250
v_mul_f32 v83, v83, v250
v_cvt_pk_bf16_f32 v84, v80, v81
v_cvt_pk_bf16_f32 v85, v82, v83
v_accvgpr_read_b32 v86, a140
v_accvgpr_read_b32 v87, a141
v_accvgpr_read_b32 v88, a142
v_accvgpr_read_b32 v89, a143
v_mul_f32 v86, v86, v250
v_mul_f32 v87, v87, v250
v_mul_f32 v88, v88, v250
v_mul_f32 v89, v89, v250
v_cvt_pk_bf16_f32 v90, v86, v87
v_cvt_pk_bf16_f32 v91, v88, v89
v_mfma_f32_16x16x32_bf16 v[40:43], a[204:207], v[172:175], v[40:43]
ds_write_b64 v94, v[84:85] offset:16384
s_waitcnt lgkmcnt(13)
ds_write_b64 v95, v[90:91] offset:16384
v_accvgpr_read_b32 v80, a144
v_accvgpr_read_b32 v81, a145
v_accvgpr_read_b32 v82, a146
v_accvgpr_read_b32 v83, a147
v_mfma_f32_16x16x32_bf16 v[44:47], a[208:211], v[160:163], 0
v_mul_f32 v80, v80, v250
v_mul_f32 v81, v81, v250
v_mul_f32 v82, v82, v250
v_mul_f32 v83, v83, v250
v_cvt_pk_bf16_f32 v84, v80, v81
v_cvt_pk_bf16_f32 v85, v82, v83
v_accvgpr_read_b32 v86, a148
v_accvgpr_read_b32 v87, a149
v_accvgpr_read_b32 v88, a150
v_accvgpr_read_b32 v89, a151
v_mul_f32 v86, v86, v250
v_mul_f32 v87, v87, v250
v_mul_f32 v88, v88, v250
v_mul_f32 v89, v89, v250
v_cvt_pk_bf16_f32 v90, v86, v87
v_cvt_pk_bf16_f32 v91, v88, v89
v_mfma_f32_16x16x32_bf16 v[44:47], a[212:215], v[164:167], v[44:47]
ds_write_b64 v96, v[84:85] offset:16384
s_waitcnt lgkmcnt(13)
ds_write_b64 v97, v[90:91] offset:16384
v_accvgpr_read_b32 v80, a152
v_accvgpr_read_b32 v81, a153
v_accvgpr_read_b32 v82, a154
v_accvgpr_read_b32 v83, a155
v_mfma_f32_16x16x32_bf16 v[44:47], a[216:219], v[168:171], v[44:47]
v_mul_f32 v80, v80, v250
v_mul_f32 v81, v81, v250
v_mul_f32 v82, v82, v250
v_mul_f32 v83, v83, v250
v_cvt_pk_bf16_f32 v84, v80, v81
v_cvt_pk_bf16_f32 v85, v82, v83
v_accvgpr_read_b32 v86, a156
v_accvgpr_read_b32 v87, a157
v_accvgpr_read_b32 v88, a158
v_accvgpr_read_b32 v89, a159
v_mul_f32 v86, v86, v250
v_mul_f32 v87, v87, v250
v_mul_f32 v88, v88, v250
v_mul_f32 v89, v89, v250
v_cvt_pk_bf16_f32 v90, v86, v87
v_cvt_pk_bf16_f32 v91, v88, v89
v_mfma_f32_16x16x32_bf16 v[44:47], a[220:223], v[172:175], v[44:47]
ds_write_b64 v98, v[84:85] offset:16384
s_waitcnt lgkmcnt(13)
ds_write_b64 v99, v[90:91] offset:16384
v_lshlrev_b32 v4, 16, v176
v_and_b32 v5, 0xffff0000, v176
v_mul_f32 v4, s24, v4
v_mul_f32 v5, s24, v5
v_cvt_pk_bf16_f32 v176, v4, v5
v_lshlrev_b32 v6, 16, v177
v_and_b32 v7, 0xffff0000, v177
v_mul_f32 v6, s24, v6
v_mul_f32 v7, s24, v7
v_max3_f32 v0, v40, v41, v42
v_cvt_pk_bf16_f32 v177, v6, v7
v_max3_f32 v0, v0, v43, v44
v_lshlrev_b32 v8, 16, v178
v_max3_f32 v0, v0, v45, v46
v_and_b32 v9, 0xffff0000, v178
v_max_f32 v0, v0, v47
v_mul_f32 v8, s24, v8
v_mov_b32 v1, v0
v_mul_f32 v9, s24, v9
s_nop 0
v_permlane16_swap_b32 v0, v1
v_cvt_pk_bf16_f32 v178, v8, v9
v_max_f32 v0, v0, v1
v_lshlrev_b32 v10, 16, v179
v_mov_b32 v1, v0
v_and_b32 v11, 0xffff0000, v179
s_nop 0
v_permlane32_swap_b32 v0, v1
v_mul_f32 v10, s24, v10
v_max_f32 v0, v0, v1
v_mul_f32 v11, s24, v11
v_sub_f32 v0, 0, v0
v_cvt_pk_bf16_f32 v179, v10, v11
v_cndmask_b32 v0, v0, v220, s[50:51]
v_lshlrev_b32 v4, 16, v180
v_mov_b32 v220, v0
v_and_b32 v5, 0xffff0000, v180
v_mov_b32 v221, v0
v_mul_f32 v4, s24, v4
v_mov_b32 v222, v0
v_mul_f32 v5, s24, v5
v_mov_b32 v223, v0
v_cvt_pk_bf16_f32 v180, v4, v5
v_add_f32 v40, v40, v0
v_lshlrev_b32 v6, 16, v181
v_add_f32 v41, v41, v0
v_and_b32 v7, 0xffff0000, v181
v_add_f32 v42, v42, v0
v_mul_f32 v6, s24, v6
v_add_f32 v43, v43, v0
v_mul_f32 v7, s24, v7
v_add_f32 v44, v44, v0
v_cvt_pk_bf16_f32 v181, v6, v7
v_add_f32 v45, v45, v0
v_lshlrev_b32 v8, 16, v182
v_add_f32 v46, v46, v0
v_and_b32 v9, 0xffff0000, v182
v_add_f32 v47, v47, v0
v_mul_f32 v8, s24, v8
v_mov_b32 v249, 0
v_mul_f32 v9, s24, v9
v_exp_f32 v40, v40
v_cvt_pk_bf16_f32 v182, v8, v9
v_exp_f32 v41, v41
v_lshlrev_b32 v10, 16, v183
v_exp_f32 v42, v42
v_and_b32 v11, 0xffff0000, v183
v_add_f32 v249, v249, v40
v_mul_f32 v10, s24, v10
v_exp_f32 v43, v43
v_mul_f32 v11, s24, v11
v_add_f32 v249, v249, v41
v_cvt_pk_bf16_f32 v183, v10, v11
v_cvt_pk_bf16_f32 v40, v40, v41
v_lshlrev_b32 v4, 16, v184
v_exp_f32 v44, v44
v_and_b32 v5, 0xffff0000, v184
v_add_f32 v249, v249, v42
v_mul_f32 v4, s24, v4
v_exp_f32 v45, v45
v_mul_f32 v5, s24, v5
v_add_f32 v249, v249, v43
v_cvt_pk_bf16_f32 v184, v4, v5
v_cvt_pk_bf16_f32 v41, v42, v43
v_lshlrev_b32 v6, 16, v185
v_exp_f32 v46, v46
v_and_b32 v7, 0xffff0000, v185
v_add_f32 v249, v249, v44
v_mul_f32 v6, s24, v6
v_exp_f32 v47, v47
v_mul_f32 v7, s24, v7
v_add_f32 v249, v249, v45
v_cvt_pk_bf16_f32 v185, v6, v7
v_cvt_pk_bf16_f32 v42, v44, v45
v_lshlrev_b32 v8, 16, v186
v_add_f32 v249, v249, v46
v_and_b32 v9, 0xffff0000, v186
v_add_f32 v249, v249, v47
v_mul_f32 v8, s24, v8
v_cvt_pk_bf16_f32 v43, v46, v47
v_mul_f32 v9, s24, v9
v_cvt_pk_bf16_f32 v186, v8, v9
v_lshlrev_b32 v10, 16, v187
v_and_b32 v11, 0xffff0000, v187
v_mul_f32 v10, s24, v10
v_mul_f32 v11, s24, v11
v_cvt_pk_bf16_f32 v187, v10, v11
v_lshlrev_b32 v4, 16, v188
v_and_b32 v5, 0xffff0000, v188
v_mul_f32 v4, s24, v4
v_mul_f32 v5, s24, v5
v_cvt_pk_bf16_f32 v188, v4, v5
v_lshlrev_b32 v6, 16, v189
v_and_b32 v7, 0xffff0000, v189
v_mul_f32 v6, s24, v6
v_mul_f32 v7, s24, v7
v_cvt_pk_bf16_f32 v189, v6, v7
v_lshlrev_b32 v8, 16, v190
v_and_b32 v9, 0xffff0000, v190
v_mul_f32 v8, s24, v8
v_mul_f32 v9, s24, v9
v_cvt_pk_bf16_f32 v190, v8, v9
v_lshlrev_b32 v10, 16, v191
v_and_b32 v11, 0xffff0000, v191
v_mul_f32 v10, s24, v10
v_mul_f32 v11, s24, v11
v_cvt_pk_bf16_f32 v191, v10, v11
v_accvgpr_read_b32 v80, a160
v_accvgpr_read_b32 v81, a161
v_accvgpr_read_b32 v82, a162
v_accvgpr_read_b32 v83, a163
v_mfma_f32_16x16x32_bf16 v[48:51], a[192:195], v[176:179], 0
v_mul_f32 v80, v80, v251
v_mul_f32 v81, v81, v251
v_mul_f32 v82, v82, v251
v_mul_f32 v83, v83, v251
v_cvt_pk_bf16_f32 v84, v80, v81
v_cvt_pk_bf16_f32 v85, v82, v83
v_accvgpr_read_b32 v86, a164
v_accvgpr_read_b32 v87, a165
v_accvgpr_read_b32 v88, a166
v_accvgpr_read_b32 v89, a167
v_mul_f32 v86, v86, v251
v_mul_f32 v87, v87, v251
v_mul_f32 v88, v88, v251
v_mul_f32 v89, v89, v251
v_cvt_pk_bf16_f32 v90, v86, v87
v_cvt_pk_bf16_f32 v91, v88, v89
v_mfma_f32_16x16x32_bf16 v[48:51], a[196:199], v[180:183], v[48:51]
ds_write_b64 v92, v[84:85] offset:20480
s_waitcnt lgkmcnt(13)
ds_write_b64 v93, v[90:91] offset:20480
v_accvgpr_read_b32 v80, a168
v_accvgpr_read_b32 v81, a169
v_accvgpr_read_b32 v82, a170
v_accvgpr_read_b32 v83, a171
v_mfma_f32_16x16x32_bf16 v[48:51], a[200:203], v[184:187], v[48:51]
v_mul_f32 v80, v80, v251
v_mul_f32 v81, v81, v251
v_mul_f32 v82, v82, v251
v_mul_f32 v83, v83, v251
v_cvt_pk_bf16_f32 v84, v80, v81
v_cvt_pk_bf16_f32 v85, v82, v83
v_accvgpr_read_b32 v86, a172
v_accvgpr_read_b32 v87, a173
v_accvgpr_read_b32 v88, a174
v_accvgpr_read_b32 v89, a175
v_mul_f32 v86, v86, v251
v_mul_f32 v87, v87, v251
v_mul_f32 v88, v88, v251
v_mul_f32 v89, v89, v251
v_cvt_pk_bf16_f32 v90, v86, v87
v_cvt_pk_bf16_f32 v91, v88, v89
v_mfma_f32_16x16x32_bf16 v[48:51], a[204:207], v[188:191], v[48:51]
ds_write_b64 v94, v[84:85] offset:20480
s_waitcnt lgkmcnt(13)
ds_write_b64 v95, v[90:91] offset:20480
v_accvgpr_read_b32 v80, a176
v_accvgpr_read_b32 v81, a177
v_accvgpr_read_b32 v82, a178
v_accvgpr_read_b32 v83, a179
v_mfma_f32_16x16x32_bf16 v[52:55], a[208:211], v[176:179], 0
v_mul_f32 v80, v80, v251
v_mul_f32 v81, v81, v251
v_mul_f32 v82, v82, v251
v_mul_f32 v83, v83, v251
v_cvt_pk_bf16_f32 v84, v80, v81
v_cvt_pk_bf16_f32 v85, v82, v83
v_accvgpr_read_b32 v86, a180
v_accvgpr_read_b32 v87, a181
v_accvgpr_read_b32 v88, a182
v_accvgpr_read_b32 v89, a183
v_mul_f32 v86, v86, v251
v_mul_f32 v87, v87, v251
v_mul_f32 v88, v88, v251
v_mul_f32 v89, v89, v251
v_cvt_pk_bf16_f32 v90, v86, v87
v_cvt_pk_bf16_f32 v91, v88, v89
v_mfma_f32_16x16x32_bf16 v[52:55], a[212:215], v[180:183], v[52:55]
ds_write_b64 v96, v[84:85] offset:20480
s_waitcnt lgkmcnt(13)
ds_write_b64 v97, v[90:91] offset:20480
v_accvgpr_read_b32 v80, a184
v_accvgpr_read_b32 v81, a185
v_accvgpr_read_b32 v82, a186
v_accvgpr_read_b32 v83, a187
v_mfma_f32_16x16x32_bf16 v[52:55], a[216:219], v[184:187], v[52:55]
v_mul_f32 v80, v80, v251
v_mul_f32 v81, v81, v251
v_mul_f32 v82, v82, v251
v_mul_f32 v83, v83, v251
v_cvt_pk_bf16_f32 v84, v80, v81
v_cvt_pk_bf16_f32 v85, v82, v83
v_accvgpr_read_b32 v86, a188
v_accvgpr_read_b32 v87, a189
v_accvgpr_read_b32 v88, a190
v_accvgpr_read_b32 v89, a191
v_mul_f32 v86, v86, v251
v_mul_f32 v87, v87, v251
v_mul_f32 v88, v88, v251
v_mul_f32 v89, v89, v251
v_cvt_pk_bf16_f32 v90, v86, v87
v_cvt_pk_bf16_f32 v91, v88, v89
v_mfma_f32_16x16x32_bf16 v[52:55], a[220:223], v[188:191], v[52:55]
ds_write_b64 v98, v[84:85] offset:20480
s_waitcnt lgkmcnt(13)
ds_write_b64 v99, v[90:91] offset:20480
v_lshlrev_b32 v4, 16, v192
v_and_b32 v5, 0xffff0000, v192
v_mul_f32 v4, s24, v4
v_mul_f32 v5, s24, v5
v_cvt_pk_bf16_f32 v192, v4, v5
v_lshlrev_b32 v6, 16, v193
v_and_b32 v7, 0xffff0000, v193
v_mul_f32 v6, s24, v6
v_mul_f32 v7, s24, v7
v_max3_f32 v0, v48, v49, v50
v_cvt_pk_bf16_f32 v193, v6, v7
v_max3_f32 v0, v0, v51, v52
v_lshlrev_b32 v8, 16, v194
v_max3_f32 v0, v0, v53, v54
v_and_b32 v9, 0xffff0000, v194
v_max_f32 v0, v0, v55
v_mul_f32 v8, s24, v8
v_mov_b32 v1, v0
v_mul_f32 v9, s24, v9
s_nop 0
v_permlane16_swap_b32 v0, v1
v_cvt_pk_bf16_f32 v194, v8, v9
v_max_f32 v0, v0, v1
v_lshlrev_b32 v10, 16, v195
v_mov_b32 v1, v0
v_and_b32 v11, 0xffff0000, v195
s_nop 0
v_permlane32_swap_b32 v0, v1
v_mul_f32 v10, s24, v10
v_max_f32 v0, v0, v1
v_mul_f32 v11, s24, v11
v_sub_f32 v0, 0, v0
v_cvt_pk_bf16_f32 v195, v10, v11
v_cndmask_b32 v0, v0, v224, s[50:51]
v_lshlrev_b32 v4, 16, v196
v_mov_b32 v224, v0
v_and_b32 v5, 0xffff0000, v196
v_mov_b32 v225, v0
v_mul_f32 v4, s24, v4
v_mov_b32 v226, v0
v_mul_f32 v5, s24, v5
v_mov_b32 v227, v0
v_cvt_pk_bf16_f32 v196, v4, v5
v_add_f32 v48, v48, v0
v_lshlrev_b32 v6, 16, v197
v_add_f32 v49, v49, v0
v_and_b32 v7, 0xffff0000, v197
v_add_f32 v50, v50, v0
v_mul_f32 v6, s24, v6
v_add_f32 v51, v51, v0
v_mul_f32 v7, s24, v7
v_add_f32 v52, v52, v0
v_cvt_pk_bf16_f32 v197, v6, v7
v_add_f32 v53, v53, v0
v_lshlrev_b32 v8, 16, v198
v_add_f32 v54, v54, v0
v_and_b32 v9, 0xffff0000, v198
v_add_f32 v55, v55, v0
v_mul_f32 v8, s24, v8
v_mov_b32 v250, 0
v_mul_f32 v9, s24, v9
v_exp_f32 v48, v48
v_cvt_pk_bf16_f32 v198, v8, v9
v_exp_f32 v49, v49
v_lshlrev_b32 v10, 16, v199
v_exp_f32 v50, v50
v_and_b32 v11, 0xffff0000, v199
v_add_f32 v250, v250, v48
v_mul_f32 v10, s24, v10
v_exp_f32 v51, v51
v_mul_f32 v11, s24, v11
v_add_f32 v250, v250, v49
v_cvt_pk_bf16_f32 v199, v10, v11
v_cvt_pk_bf16_f32 v48, v48, v49
v_lshlrev_b32 v4, 16, v200
v_exp_f32 v52, v52
v_and_b32 v5, 0xffff0000, v200
v_add_f32 v250, v250, v50
v_mul_f32 v4, s24, v4
v_exp_f32 v53, v53
v_mul_f32 v5, s24, v5
v_add_f32 v250, v250, v51
v_cvt_pk_bf16_f32 v200, v4, v5
v_cvt_pk_bf16_f32 v49, v50, v51
v_lshlrev_b32 v6, 16, v201
v_exp_f32 v54, v54
v_and_b32 v7, 0xffff0000, v201
v_add_f32 v250, v250, v52
v_mul_f32 v6, s24, v6
v_exp_f32 v55, v55
v_mul_f32 v7, s24, v7
v_add_f32 v250, v250, v53
v_cvt_pk_bf16_f32 v201, v6, v7
v_cvt_pk_bf16_f32 v50, v52, v53
v_lshlrev_b32 v8, 16, v202
v_add_f32 v250, v250, v54
v_and_b32 v9, 0xffff0000, v202
v_add_f32 v250, v250, v55
v_mul_f32 v8, s24, v8
v_cvt_pk_bf16_f32 v51, v54, v55
v_mul_f32 v9, s24, v9
v_cvt_pk_bf16_f32 v202, v8, v9
v_lshlrev_b32 v10, 16, v203
v_and_b32 v11, 0xffff0000, v203
v_mul_f32 v10, s24, v10
v_mul_f32 v11, s24, v11
v_cvt_pk_bf16_f32 v203, v10, v11
v_lshlrev_b32 v4, 16, v204
v_and_b32 v5, 0xffff0000, v204
v_mul_f32 v4, s24, v4
v_mul_f32 v5, s24, v5
v_cvt_pk_bf16_f32 v204, v4, v5
v_lshlrev_b32 v6, 16, v205
v_and_b32 v7, 0xffff0000, v205
v_mul_f32 v6, s24, v6
v_mul_f32 v7, s24, v7
v_cvt_pk_bf16_f32 v205, v6, v7
v_lshlrev_b32 v8, 16, v206
v_and_b32 v9, 0xffff0000, v206
v_mul_f32 v8, s24, v8
v_mul_f32 v9, s24, v9
v_cvt_pk_bf16_f32 v206, v8, v9
v_lshlrev_b32 v10, 16, v207
v_and_b32 v11, 0xffff0000, v207
v_mul_f32 v10, s24, v10
v_mul_f32 v11, s24, v11
v_cvt_pk_bf16_f32 v207, v10, v11
v_mov_b32 v4, v100
v_mov_b32 v5, v101
v_mov_b32 v6, v102
v_mov_b32 v7, v103
s_mov_b32 s32, s27
s_mov_b32 s35, 1
v_mfma_f32_16x16x32_bf16 v[56:59], a[192:195], v[192:195], 0
v_mfma_f32_16x16x32_bf16 v[56:59], a[196:199], v[196:199], v[56:59]
v_mfma_f32_16x16x32_bf16 v[56:59], a[200:203], v[200:203], v[56:59]
v_mfma_f32_16x16x32_bf16 v[56:59], a[204:207], v[204:207], v[56:59]
v_mfma_f32_16x16x32_bf16 v[60:63], a[208:211], v[192:195], 0
v_mfma_f32_16x16x32_bf16 v[60:63], a[212:215], v[196:199], v[60:63]
v_mfma_f32_16x16x32_bf16 v[60:63], a[216:219], v[200:203], v[60:63]
v_mfma_f32_16x16x32_bf16 v[60:63], a[220:223], v[204:207], v[60:63]
s_mov_b32 s39, 1
s_add_u32 s26, s26, 0x18000
s_mov_b32 s38, 0x30000
s_branch L_body
L_final:
s_nop 7
v_mov_b32 v8, v246
v_mov_b32 v9, v247
v_mov_b32 v10, v248
v_mov_b32 v11, v249
v_mov_b32 v12, v250
v_mov_b32 v13, v251
s_nop 0
v_permlane16_swap_b32 v246, v8
v_permlane16_swap_b32 v247, v9
v_permlane16_swap_b32 v248, v10
v_permlane16_swap_b32 v249, v11
v_permlane16_swap_b32 v250, v12
v_permlane16_swap_b32 v251, v13
s_nop 0
v_add_f32 v246, v246, v8
v_add_f32 v247, v247, v9
v_add_f32 v248, v248, v10
v_add_f32 v249, v249, v11
v_add_f32 v250, v250, v12
v_add_f32 v251, v251, v13
v_mov_b32 v8, v246
v_mov_b32 v9, v247
v_mov_b32 v10, v248
v_mov_b32 v11, v249
v_mov_b32 v12, v250
v_mov_b32 v13, v251
s_nop 0
v_permlane32_swap_b32 v246, v8
v_permlane32_swap_b32 v247, v9
v_permlane32_swap_b32 v248, v10
v_permlane32_swap_b32 v249, v11
v_permlane32_swap_b32 v250, v12
v_permlane32_swap_b32 v251, v13
s_nop 0
v_add_f32 v246, v246, v8
v_add_f32 v247, v247, v9
v_add_f32 v248, v248, v10
v_add_f32 v249, v249, v11
v_add_f32 v250, v250, v12
v_add_f32 v251, v251, v13
v_add_f32 v0, v246, v247
v_add_f32 v0, v0, v248
v_add_f32 v0, v0, v249
v_add_f32 v0, v0, v250
v_add_f32 v0, v0, v251
s_mov_b32 s30, 0x4f800000
v_cmp_nge_f32 vcc, s30, v0
s_lshl_b32 s31, 1, s47
v_rcp_f32 v246, v246
v_rcp_f32 v247, v247
v_rcp_f32 v248, v248
v_rcp_f32 v249, v249
v_rcp_f32 v250, v250
v_rcp_f32 v251, v251
s_cmp_lg_u64 vcc, 0
s_cselect_b32 s31, s31, 0
s_or_b32 s43, s43, s31
v_mbcnt_lo_u32_b32 v0, -1, 0
v_mbcnt_hi_u32_b32 v0, -1, v0
v_and_b32 v2, 15, v0
v_lshrrev_b32 v3, 4, v0
v_lshlrev_b32 v4, 1, v2
v_xor_b32 v4, v4, v3
v_lshlrev_b32 v4, 3, v4
v_lshl_add_u32 v4, v2, 8, v4
v_add_u32 v4, s40, v4
v_xor_b32 v92, 0x0, v4
v_xor_b32 v93, 0x20, v4
v_xor_b32 v94, 0x40, v4
v_xor_b32 v95, 0x60, v4
v_xor_b32 v96, 0x80, v4
v_xor_b32 v97, 0xa0, v4
v_xor_b32 v98, 0xc0, v4
v_xor_b32 v99, 0xe0, v4
v_xor_b32 v4, v2, v3
v_lshlrev_b32 v4, 4, v4
v_lshl_add_u32 v4, v3, 8, v4
v_add_u32 v4, s40, v4
v_xor_b32 v100, 0x0, v4
v_xor_b32 v101, 0x40, v4
v_xor_b32 v102, 0x80, v4
v_xor_b32 v103, 0xc0, v4
v_accvgpr_read_b32 v80, a0
v_accvgpr_read_b32 v81, a1
v_accvgpr_read_b32 v82, a2
v_accvgpr_read_b32 v83, a3
v_mul_f32 v80, v80, v246
v_mul_f32 v81, v81, v246
v_mul_f32 v82, v82, v246
v_mul_f32 v83, v83, v246
v_cvt_pk_bf16_f32 v84, v80, v81
v_cvt_pk_bf16_f32 v85, v82, v83
v_accvgpr_read_b32 v86, a4
v_accvgpr_read_b32 v87, a5
v_accvgpr_read_b32 v88, a6
v_accvgpr_read_b32 v89, a7
v_mul_f32 v86, v86, v246
v_mul_f32 v87, v87, v246
v_mul_f32 v88, v88, v246
v_mul_f32 v89, v89, v246
v_cvt_pk_bf16_f32 v90, v86, v87
v_cvt_pk_bf16_f32 v91, v88, v89
ds_write_b64 v92, v[84:85] offset:0
ds_write_b64 v93, v[90:91] offset:0
v_accvgpr_read_b32 v80, a8
v_accvgpr_read_b32 v81, a9
v_accvgpr_read_b32 v82, a10
v_accvgpr_read_b32 v83, a11
v_mul_f32 v80, v80, v246
v_mul_f32 v81, v81, v246
v_mul_f32 v82, v82, v246
v_mul_f32 v83, v83, v246
v_cvt_pk_bf16_f32 v84, v80, v81
v_cvt_pk_bf16_f32 v85, v82, v83
v_accvgpr_read_b32 v86, a12
v_accvgpr_read_b32 v87, a13
v_accvgpr_read_b32 v88, a14
v_accvgpr_read_b32 v89, a15
v_mul_f32 v86, v86, v246
v_mul_f32 v87, v87, v246
v_mul_f32 v88, v88, v246
v_mul_f32 v89, v89, v246
v_cvt_pk_bf16_f32 v90, v86, v87
v_cvt_pk_bf16_f32 v91, v88, v89
ds_write_b64 v94, v[84:85] offset:0
ds_write_b64 v95, v[90:91] offset:0
v_accvgpr_read_b32 v80, a16
v_accvgpr_read_b32 v81, a17
v_accvgpr_read_b32 v82, a18
v_accvgpr_read_b32 v83, a19
v_mul_f32 v80, v80, v246
v_mul_f32 v81, v81, v246
v_mul_f32 v82, v82, v246
v_mul_f32 v83, v83, v246
v_cvt_pk_bf16_f32 v84, v80, v81
v_cvt_pk_bf16_f32 v85, v82, v83
v_accvgpr_read_b32 v86, a20
v_accvgpr_read_b32 v87, a21
v_accvgpr_read_b32 v88, a22
v_accvgpr_read_b32 v89, a23
v_mul_f32 v86, v86, v246
v_mul_f32 v87, v87, v246
v_mul_f32 v88, v88, v246
v_mul_f32 v89, v89, v246
v_cvt_pk_bf16_f32 v90, v86, v87
v_cvt_pk_bf16_f32 v91, v88, v89
ds_write_b64 v96, v[84:85] offset:0
ds_write_b64 v97, v[90:91] offset:0
v_accvgpr_read_b32 v80, a24
v_accvgpr_read_b32 v81, a25
v_accvgpr_read_b32 v82, a26
v_accvgpr_read_b32 v83, a27
v_mul_f32 v80, v80, v246
v_mul_f32 v81, v81, v246
v_mul_f32 v82, v82, v246
v_mul_f32 v83, v83, v246
v_cvt_pk_bf16_f32 v84, v80, v81
v_cvt_pk_bf16_f32 v85, v82, v83
v_accvgpr_read_b32 v86, a28
v_accvgpr_read_b32 v87, a29
v_accvgpr_read_b32 v88, a30
v_accvgpr_read_b32 v89, a31
v_mul_f32 v86, v86, v246
v_mul_f32 v87, v87, v246
v_mul_f32 v88, v88, v246
v_mul_f32 v89, v89, v246
v_cvt_pk_bf16_f32 v90, v86, v87
v_cvt_pk_bf16_f32 v91, v88, v89
ds_write_b64 v98, v[84:85] offset:0
ds_write_b64 v99, v[90:91] offset:0
ds_read_b128 v[64:67], v100 offset:0
ds_read_b128 v[68:71], v101 offset:1024
ds_read_b128 v[72:75], v102 offset:2048
ds_read_b128 v[76:79], v103 offset:3072
v_accvgpr_read_b32 v80, a32
v_accvgpr_read_b32 v81, a33
v_accvgpr_read_b32 v82, a34
v_accvgpr_read_b32 v83, a35
v_mul_f32 v80, v80, v247
v_mul_f32 v81, v81, v247
v_mul_f32 v82, v82, v247
v_mul_f32 v83, v83, v247
v_cvt_pk_bf16_f32 v84, v80, v81
v_cvt_pk_bf16_f32 v85, v82, v83
v_accvgpr_read_b32 v86, a36
v_accvgpr_read_b32 v87, a37
v_accvgpr_read_b32 v88, a38
v_accvgpr_read_b32 v89, a39
v_mul_f32 v86, v86, v247
v_mul_f32 v87, v87, v247
v_mul_f32 v88, v88, v247
v_mul_f32 v89, v89, v247
v_cvt_pk_bf16_f32 v90, v86, v87
v_cvt_pk_bf16_f32 v91, v88, v89
ds_write_b64 v92, v[84:85] offset:4096
ds_write_b64 v93, v[90:91] offset:4096
s_add_u32 s48, s27, 0x0
s_waitcnt lgkmcnt(5)
buffer_store_dwordx4 v[64:67], v245, s[16:19], s48 offen offset:0 sc1 nt
v_accvgpr_read_b32 v80, a40
v_accvgpr_read_b32 v81, a41
v_accvgpr_read_b32 v82, a42
v_accvgpr_read_b32 v83, a43
v_mul_f32 v80, v80, v247
v_mul_f32 v81, v81, v247
v_mul_f32 v82, v82, v247
v_mul_f32 v83, v83, v247
v_cvt_pk_bf16_f32 v84, v80, v81
v_cvt_pk_bf16_f32 v85, v82, v83
v_accvgpr_read_b32 v86, a44
v_accvgpr_read_b32 v87, a45
v_accvgpr_read_b32 v88, a46
v_accvgpr_read_b32 v89, a47
v_mul_f32 v86, v86, v247
v_mul_f32 v87, v87, v247
v_mul_f32 v88, v88, v247
v_mul_f32 v89, v89, v247
v_cvt_pk_bf16_f32 v90, v86, v87
v_cvt_pk_bf16_f32 v91, v88, v89
ds_write_b64 v94, v[84:85] offset:4096
ds_write_b64 v95, v[90:91] offset:4096
s_waitcnt lgkmcnt(6)
buffer_store_dwordx4 v[68:71], v245, s[16:19], s48 offen offset:1024 sc1 nt
v_accvgpr_read_b32 v80, a48
v_accvgpr_read_b32 v81, a49
v_accvgpr_read_b32 v82, a50
v_accvgpr_read_b32 v83, a51
v_mul_f32 v80, v80, v247
v_mul_f32 v81, v81, v247
v_mul_f32 v82, v82, v247
v_mul_f32 v83, v83, v247
v_cvt_pk_bf16_f32 v84, v80, v81
v_cvt_pk_bf16_f32 v85, v82, v83
v_accvgpr_read_b32 v86, a52
v_accvgpr_read_b32 v87, a53
v_accvgpr_read_b32 v88, a54
v_accvgpr_read_b32 v89, a55
v_mul_f32 v86, v86, v247
v_mul_f32 v87, v87, v247
v_mul_f32 v88, v88, v247
v_mul_f32 v89, v89, v247
v_cvt_pk_bf16_f32 v90, v86, v87
v_cvt_pk_bf16_f32 v91, v88, v89
ds_write_b64 v96, v[84:85] offset:4096
ds_write_b64 v97, v[90:91] offset:4096
s_waitcnt lgkmcnt(7)
buffer_store_dwordx4 v[72:75], v245, s[16:19], s48 offen offset:2048 sc1 nt
v_accvgpr_read_b32 v80, a56
v_accvgpr_read_b32 v81, a57
v_accvgpr_read_b32 v82, a58
v_accvgpr_read_b32 v83, a59
v_mul_f32 v80, v80, v247
v_mul_f32 v81, v81, v247
v_mul_f32 v82, v82, v247
v_mul_f32 v83, v83, v247
v_cvt_pk_bf16_f32 v84, v80, v81
v_cvt_pk_bf16_f32 v85, v82, v83
v_accvgpr_read_b32 v86, a60
v_accvgpr_read_b32 v87, a61
v_accvgpr_read_b32 v88, a62
v_accvgpr_read_b32 v89, a63
v_mul_f32 v86, v86, v247
v_mul_f32 v87, v87, v247
v_mul_f32 v88, v88, v247
v_mul_f32 v89, v89, v247
v_cvt_pk_bf16_f32 v90, v86, v87
v_cvt_pk_bf16_f32 v91, v88, v89
ds_write_b64 v98, v[84:85] offset:4096
ds_write_b64 v99, v[90:91] offset:4096
s_waitcnt lgkmcnt(8)
buffer_store_dwordx4 v[76:79], v245, s[16:19], s48 offen offset:3072 sc1 nt
ds_read_b128 v[64:67], v100 offset:4096
ds_read_b128 v[68:71], v101 offset:5120
ds_read_b128 v[72:75], v102 offset:6144
ds_read_b128 v[76:79], v103 offset:7168
v_accvgpr_read_b32 v80, a64
v_accvgpr_read_b32 v81, a65
v_accvgpr_read_b32 v82, a66
v_accvgpr_read_b32 v83, a67
v_mul_f32 v80, v80, v248
v_mul_f32 v81, v81, v248
v_mul_f32 v82, v82, v248
v_mul_f32 v83, v83, v248
v_cvt_pk_bf16_f32 v84, v80, v81
v_cvt_pk_bf16_f32 v85, v82, v83
v_accvgpr_read_b32 v86, a68
v_accvgpr_read_b32 v87, a69
v_accvgpr_read_b32 v88, a70
v_accvgpr_read_b32 v89, a71
v_mul_f32 v86, v86, v248
v_mul_f32 v87, v87, v248
v_mul_f32 v88, v88, v248
v_mul_f32 v89, v89, v248
v_cvt_pk_bf16_f32 v90, v86, v87
v_cvt_pk_bf16_f32 v91, v88, v89
ds_write_b64 v92, v[84:85] offset:0
ds_write_b64 v93, v[90:91] offset:0
s_add_u32 s48, s27, 0x1000
s_waitcnt lgkmcnt(5)
buffer_store_dwordx4 v[64:67], v245, s[16:19], s48 offen offset:0 sc1 nt
v_accvgpr_read_b32 v80, a72
v_accvgpr_read_b32 v81, a73
v_accvgpr_read_b32 v82, a74
v_accvgpr_read_b32 v83, a75
v_mul_f32 v80, v80, v248
v_mul_f32 v81, v81, v248
v_mul_f32 v82, v82, v248
v_mul_f32 v83, v83, v248
v_cvt_pk_bf16_f32 v84, v80, v81
v_cvt_pk_bf16_f32 v85, v82, v83
v_accvgpr_read_b32 v86, a76
v_accvgpr_read_b32 v87, a77
v_accvgpr_read_b32 v88, a78
v_accvgpr_read_b32 v89, a79
v_mul_f32 v86, v86, v248
v_mul_f32 v87, v87, v248
v_mul_f32 v88, v88, v248
v_mul_f32 v89, v89, v248
v_cvt_pk_bf16_f32 v90, v86, v87
v_cvt_pk_bf16_f32 v91, v88, v89
ds_write_b64 v94, v[84:85] offset:0
ds_write_b64 v95, v[90:91] offset:0
s_waitcnt lgkmcnt(6)
buffer_store_dwordx4 v[68:71], v245, s[16:19], s48 offen offset:1024 sc1 nt
v_accvgpr_read_b32 v80, a80
v_accvgpr_read_b32 v81, a81
v_accvgpr_read_b32 v82, a82
v_accvgpr_read_b32 v83, a83
v_mul_f32 v80, v80, v248
v_mul_f32 v81, v81, v248
v_mul_f32 v82, v82, v248
v_mul_f32 v83, v83, v248
v_cvt_pk_bf16_f32 v84, v80, v81
v_cvt_pk_bf16_f32 v85, v82, v83
v_accvgpr_read_b32 v86, a84
v_accvgpr_read_b32 v87, a85
v_accvgpr_read_b32 v88, a86
v_accvgpr_read_b32 v89, a87
v_mul_f32 v86, v86, v248
v_mul_f32 v87, v87, v248
v_mul_f32 v88, v88, v248
v_mul_f32 v89, v89, v248
v_cvt_pk_bf16_f32 v90, v86, v87
v_cvt_pk_bf16_f32 v91, v88, v89
ds_write_b64 v96, v[84:85] offset:0
ds_write_b64 v97, v[90:91] offset:0
s_waitcnt lgkmcnt(7)
buffer_store_dwordx4 v[72:75], v245, s[16:19], s48 offen offset:2048 sc1 nt
v_accvgpr_read_b32 v80, a88
v_accvgpr_read_b32 v81, a89
v_accvgpr_read_b32 v82, a90
v_accvgpr_read_b32 v83, a91
v_mul_f32 v80, v80, v248
v_mul_f32 v81, v81, v248
v_mul_f32 v82, v82, v248
v_mul_f32 v83, v83, v248
v_cvt_pk_bf16_f32 v84, v80, v81
v_cvt_pk_bf16_f32 v85, v82, v83
v_accvgpr_read_b32 v86, a92
v_accvgpr_read_b32 v87, a93
v_accvgpr_read_b32 v88, a94
v_accvgpr_read_b32 v89, a95
v_mul_f32 v86, v86, v248
v_mul_f32 v87, v87, v248
v_mul_f32 v88, v88, v248
v_mul_f32 v89, v89, v248
v_cvt_pk_bf16_f32 v90, v86, v87
v_cvt_pk_bf16_f32 v91, v88, v89
ds_write_b64 v98, v[84:85] offset:0
ds_write_b64 v99, v[90:91] offset:0
s_waitcnt lgkmcnt(8)
buffer_store_dwordx4 v[76:79], v245, s[16:19], s48 offen offset:3072 sc1 nt
ds_read_b128 v[64:67], v100 offset:0
ds_read_b128 v[68:71], v101 offset:1024
ds_read_b128 v[72:75], v102 offset:2048
ds_read_b128 v[76:79], v103 offset:3072
v_accvgpr_read_b32 v80, a96
v_accvgpr_read_b32 v81, a97
v_accvgpr_read_b32 v82, a98
v_accvgpr_read_b32 v83, a99
v_mul_f32 v80, v80, v249
v_mul_f32 v81, v81, v249
v_mul_f32 v82, v82, v249
v_mul_f32 v83, v83, v249
v_cvt_pk_bf16_f32 v84, v80, v81
v_cvt_pk_bf16_f32 v85, v82, v83
v_accvgpr_read_b32 v86, a100
v_accvgpr_read_b32 v87, a101
v_accvgpr_read_b32 v88, a102
v_accvgpr_read_b32 v89, a103
v_mul_f32 v86, v86, v249
v_mul_f32 v87, v87, v249
v_mul_f32 v88, v88, v249
v_mul_f32 v89, v89, v249
v_cvt_pk_bf16_f32 v90, v86, v87
v_cvt_pk_bf16_f32 v91, v88, v89
ds_write_b64 v92, v[84:85] offset:4096
ds_write_b64 v93, v[90:91] offset:4096
s_add_u32 s48, s27, 0x2000
s_waitcnt lgkmcnt(5)
buffer_store_dwordx4 v[64:67], v245, s[16:19], s48 offen offset:0 sc1 nt
v_accvgpr_read_b32 v80, a104
v_accvgpr_read_b32 v81, a105
v_accvgpr_read_b32 v82, a106
v_accvgpr_read_b32 v83, a107
v_mul_f32 v80, v80, v249
v_mul_f32 v81, v81, v249
v_mul_f32 v82, v82, v249
v_mul_f32 v83, v83, v249
v_cvt_pk_bf16_f32 v84, v80, v81
v_cvt_pk_bf16_f32 v85, v82, v83
v_accvgpr_read_b32 v86, a108
v_accvgpr_read_b32 v87, a109
v_accvgpr_read_b32 v88, a110
v_accvgpr_read_b32 v89, a111
v_mul_f32 v86, v86, v249
v_mul_f32 v87, v87, v249
v_mul_f32 v88, v88, v249
v_mul_f32 v89, v89, v249
v_cvt_pk_bf16_f32 v90, v86, v87
v_cvt_pk_bf16_f32 v91, v88, v89
ds_write_b64 v94, v[84:85] offset:4096
ds_write_b64 v95, v[90:91] offset:4096
s_waitcnt lgkmcnt(6)
buffer_store_dwordx4 v[68:71], v245, s[16:19], s48 offen offset:1024 sc1 nt
v_accvgpr_read_b32 v80, a112
v_accvgpr_read_b32 v81, a113
v_accvgpr_read_b32 v82, a114
v_accvgpr_read_b32 v83, a115
v_mul_f32 v80, v80, v249
v_mul_f32 v81, v81, v249
v_mul_f32 v82, v82, v249
v_mul_f32 v83, v83, v249
v_cvt_pk_bf16_f32 v84, v80, v81
v_cvt_pk_bf16_f32 v85, v82, v83
v_accvgpr_read_b32 v86, a116
v_accvgpr_read_b32 v87, a117
v_accvgpr_read_b32 v88, a118
v_accvgpr_read_b32 v89, a119
v_mul_f32 v86, v86, v249
v_mul_f32 v87, v87, v249
v_mul_f32 v88, v88, v249
v_mul_f32 v89, v89, v249
v_cvt_pk_bf16_f32 v90, v86, v87
v_cvt_pk_bf16_f32 v91, v88, v89
ds_write_b64 v96, v[84:85] offset:4096
ds_write_b64 v97, v[90:91] offset:4096
s_waitcnt lgkmcnt(7)
buffer_store_dwordx4 v[72:75], v245, s[16:19], s48 offen offset:2048 sc1 nt
v_accvgpr_read_b32 v80, a120
v_accvgpr_read_b32 v81, a121
v_accvgpr_read_b32 v82, a122
v_accvgpr_read_b32 v83, a123
v_mul_f32 v80, v80, v249
v_mul_f32 v81, v81, v249
v_mul_f32 v82, v82, v249
v_mul_f32 v83, v83, v249
v_cvt_pk_bf16_f32 v84, v80, v81
v_cvt_pk_bf16_f32 v85, v82, v83
v_accvgpr_read_b32 v86, a124
v_accvgpr_read_b32 v87, a125
v_accvgpr_read_b32 v88, a126
v_accvgpr_read_b32 v89, a127
v_mul_f32 v86, v86, v249
v_mul_f32 v87, v87, v249
v_mul_f32 v88, v88, v249
v_mul_f32 v89, v89, v249
v_cvt_pk_bf16_f32 v90, v86, v87
v_cvt_pk_bf16_f32 v91, v88, v89
ds_write_b64 v98, v[84:85] offset:4096
ds_write_b64 v99, v[90:91] offset:4096
s_waitcnt lgkmcnt(8)
buffer_store_dwordx4 v[76:79], v245, s[16:19], s48 offen offset:3072 sc1 nt
ds_read_b128 v[64:67], v100 offset:4096
ds_read_b128 v[68:71], v101 offset:5120
ds_read_b128 v[72:75], v102 offset:6144
ds_read_b128 v[76:79], v103 offset:7168
v_accvgpr_read_b32 v80, a128
v_accvgpr_read_b32 v81, a129
v_accvgpr_read_b32 v82, a130
v_accvgpr_read_b32 v83, a131
v_mul_f32 v80, v80, v250
v_mul_f32 v81, v81, v250
v_mul_f32 v82, v82, v250
v_mul_f32 v83, v83, v250
v_cvt_pk_bf16_f32 v84, v80, v81
v_cvt_pk_bf16_f32 v85, v82, v83
v_accvgpr_read_b32 v86, a132
v_accvgpr_read_b32 v87, a133
v_accvgpr_read_b32 v88, a134
v_accvgpr_read_b32 v89, a135
v_mul_f32 v86, v86, v250
v_mul_f32 v87, v87, v250
v_mul_f32 v88, v88, v250
v_mul_f32 v89, v89, v250
v_cvt_pk_bf16_f32 v90, v86, v87
v_cvt_pk_bf16_f32 v91, v88, v89
ds_write_b64 v92, v[84:85] offset:0
ds_write_b64 v93, v[90:91] offset:0
s_add_u32 s48, s27, 0x3000
s_waitcnt lgkmcnt(5)
buffer_store_dwordx4 v[64:67], v245, s[16:19], s48 offen offset:0 sc1 nt
v_accvgpr_read_b32 v80, a136
v_accvgpr_read_b32 v81, a137
v_accvgpr_read_b32 v82, a138
v_accvgpr_read_b32 v83, a139
v_mul_f32 v80, v80, v250
v_mul_f32 v81, v81, v250
v_mul_f32 v82, v82, v250
v_mul_f32 v83, v83, v250
v_cvt_pk_bf16_f32 v84, v80, v81
v_cvt_pk_bf16_f32 v85, v82, v83
v_accvgpr_read_b32 v86, a140
v_accvgpr_read_b32 v87, a141
v_accvgpr_read_b32 v88, a142
v_accvgpr_read_b32 v89, a143
v_mul_f32 v86, v86, v250
v_mul_f32 v87, v87, v250
v_mul_f32 v88, v88, v250
v_mul_f32 v89, v89, v250
v_cvt_pk_bf16_f32 v90, v86, v87
v_cvt_pk_bf16_f32 v91, v88, v89
ds_write_b64 v94, v[84:85] offset:0
ds_write_b64 v95, v[90:91] offset:0
s_waitcnt lgkmcnt(6)
buffer_store_dwordx4 v[68:71], v245, s[16:19], s48 offen offset:1024 sc1 nt
v_accvgpr_read_b32 v80, a144
v_accvgpr_read_b32 v81, a145
v_accvgpr_read_b32 v82, a146
v_accvgpr_read_b32 v83, a147
v_mul_f32 v80, v80, v250
v_mul_f32 v81, v81, v250
v_mul_f32 v82, v82, v250
v_mul_f32 v83, v83, v250
v_cvt_pk_bf16_f32 v84, v80, v81
v_cvt_pk_bf16_f32 v85, v82, v83
v_accvgpr_read_b32 v86, a148
v_accvgpr_read_b32 v87, a149
v_accvgpr_read_b32 v88, a150
v_accvgpr_read_b32 v89, a151
v_mul_f32 v86, v86, v250
v_mul_f32 v87, v87, v250
v_mul_f32 v88, v88, v250
v_mul_f32 v89, v89, v250
v_cvt_pk_bf16_f32 v90, v86, v87
v_cvt_pk_bf16_f32 v91, v88, v89
ds_write_b64 v96, v[84:85] offset:0
ds_write_b64 v97, v[90:91] offset:0
s_waitcnt lgkmcnt(7)
buffer_store_dwordx4 v[72:75], v245, s[16:19], s48 offen offset:2048 sc1 nt
v_accvgpr_read_b32 v80, a152
v_accvgpr_read_b32 v81, a153
v_accvgpr_read_b32 v82, a154
v_accvgpr_read_b32 v83, a155
v_mul_f32 v80, v80, v250
v_mul_f32 v81, v81, v250
v_mul_f32 v82, v82, v250
v_mul_f32 v83, v83, v250
v_cvt_pk_bf16_f32 v84, v80, v81
v_cvt_pk_bf16_f32 v85, v82, v83
v_accvgpr_read_b32 v86, a156
v_accvgpr_read_b32 v87, a157
v_accvgpr_read_b32 v88, a158
v_accvgpr_read_b32 v89, a159
v_mul_f32 v86, v86, v250
v_mul_f32 v87, v87, v250
v_mul_f32 v88, v88, v250
v_mul_f32 v89, v89, v250
v_cvt_pk_bf16_f32 v90, v86, v87
v_cvt_pk_bf16_f32 v91, v88, v89
ds_write_b64 v98, v[84:85] offset:0
ds_write_b64 v99, v[90:91] offset:0
s_waitcnt lgkmcnt(8)
buffer_store_dwordx4 v[76:79], v245, s[16:19], s48 offen offset:3072 sc1 nt
ds_read_b128 v[64:67], v100 offset:0
ds_read_b128 v[68:71], v101 offset:1024
ds_read_b128 v[72:75], v102 offset:2048
ds_read_b128 v[76:79], v103 offset:3072
v_accvgpr_read_b32 v80, a160
v_accvgpr_read_b32 v81, a161
v_accvgpr_read_b32 v82, a162
v_accvgpr_read_b32 v83, a163
v_mul_f32 v80, v80, v251
v_mul_f32 v81, v81, v251
v_mul_f32 v82, v82, v251
v_mul_f32 v83, v83, v251
v_cvt_pk_bf16_f32 v84, v80, v81
v_cvt_pk_bf16_f32 v85, v82, v83
v_accvgpr_read_b32 v86, a164
v_accvgpr_read_b32 v87, a165
v_accvgpr_read_b32 v88, a166
v_accvgpr_read_b32 v89, a167
v_mul_f32 v86, v86, v251
v_mul_f32 v87, v87, v251
v_mul_f32 v88, v88, v251
v_mul_f32 v89, v89, v251
v_cvt_pk_bf16_f32 v90, v86, v87
v_cvt_pk_bf16_f32 v91, v88, v89
ds_write_b64 v92, v[84:85] offset:4096
ds_write_b64 v93, v[90:91] offset:4096
s_add_u32 s48, s27, 0x4000
s_waitcnt lgkmcnt(5)
buffer_store_dwordx4 v[64:67], v245, s[16:19], s48 offen offset:0 sc1 nt
v_accvgpr_read_b32 v80, a168
v_accvgpr_read_b32 v81, a169
v_accvgpr_read_b32 v82, a170
v_accvgpr_read_b32 v83, a171
v_mul_f32 v80, v80, v251
v_mul_f32 v81, v81, v251
v_mul_f32 v82, v82, v251
v_mul_f32 v83, v83, v251
v_cvt_pk_bf16_f32 v84, v80, v81
v_cvt_pk_bf16_f32 v85, v82, v83
v_accvgpr_read_b32 v86, a172
v_accvgpr_read_b32 v87, a173
v_accvgpr_read_b32 v88, a174
v_accvgpr_read_b32 v89, a175
v_mul_f32 v86, v86, v251
v_mul_f32 v87, v87, v251
v_mul_f32 v88, v88, v251
v_mul_f32 v89, v89, v251
v_cvt_pk_bf16_f32 v90, v86, v87
v_cvt_pk_bf16_f32 v91, v88, v89
ds_write_b64 v94, v[84:85] offset:4096
ds_write_b64 v95, v[90:91] offset:4096
s_waitcnt lgkmcnt(6)
buffer_store_dwordx4 v[68:71], v245, s[16:19], s48 offen offset:1024 sc1 nt
v_accvgpr_read_b32 v80, a176
v_accvgpr_read_b32 v81, a177
v_accvgpr_read_b32 v82, a178
v_accvgpr_read_b32 v83, a179
v_mul_f32 v80, v80, v251
v_mul_f32 v81, v81, v251
v_mul_f32 v82, v82, v251
v_mul_f32 v83, v83, v251
v_cvt_pk_bf16_f32 v84, v80, v81
v_cvt_pk_bf16_f32 v85, v82, v83
v_accvgpr_read_b32 v86, a180
v_accvgpr_read_b32 v87, a181
v_accvgpr_read_b32 v88, a182
v_accvgpr_read_b32 v89, a183
v_mul_f32 v86, v86, v251
v_mul_f32 v87, v87, v251
v_mul_f32 v88, v88, v251
v_mul_f32 v89, v89, v251
v_cvt_pk_bf16_f32 v90, v86, v87
v_cvt_pk_bf16_f32 v91, v88, v89
ds_write_b64 v96, v[84:85] offset:4096
ds_write_b64 v97, v[90:91] offset:4096
s_waitcnt lgkmcnt(7)
buffer_store_dwordx4 v[72:75], v245, s[16:19], s48 offen offset:2048 sc1 nt
v_accvgpr_read_b32 v80, a184
v_accvgpr_read_b32 v81, a185
v_accvgpr_read_b32 v82, a186
v_accvgpr_read_b32 v83, a187
v_mul_f32 v80, v80, v251
v_mul_f32 v81, v81, v251
v_mul_f32 v82, v82, v251
v_mul_f32 v83, v83, v251
v_cvt_pk_bf16_f32 v84, v80, v81
v_cvt_pk_bf16_f32 v85, v82, v83
v_accvgpr_read_b32 v86, a188
v_accvgpr_read_b32 v87, a189
v_accvgpr_read_b32 v88, a190
v_accvgpr_read_b32 v89, a191
v_mul_f32 v86, v86, v251
v_mul_f32 v87, v87, v251
v_mul_f32 v88, v88, v251
v_mul_f32 v89, v89, v251
v_cvt_pk_bf16_f32 v90, v86, v87
v_cvt_pk_bf16_f32 v91, v88, v89
ds_write_b64 v98, v[84:85] offset:4096
ds_write_b64 v99, v[90:91] offset:4096
s_waitcnt lgkmcnt(8)
buffer_store_dwordx4 v[76:79], v245, s[16:19], s48 offen offset:3072 sc1 nt
ds_read_b128 v[64:67], v100 offset:4096
ds_read_b128 v[68:71], v101 offset:5120
ds_read_b128 v[72:75], v102 offset:6144
ds_read_b128 v[76:79], v103 offset:7168
s_add_u32 s48, s27, 0x5000
s_waitcnt lgkmcnt(3)
buffer_store_dwordx4 v[64:67], v245, s[16:19], s48 offen offset:0 sc1 nt
s_waitcnt lgkmcnt(2)
buffer_store_dwordx4 v[68:71], v245, s[16:19], s48 offen offset:1024 sc1 nt
s_waitcnt lgkmcnt(1)
buffer_store_dwordx4 v[72:75], v245, s[16:19], s48 offen offset:2048 sc1 nt
s_waitcnt lgkmcnt(0)
buffer_store_dwordx4 v[76:79], v245, s[16:19], s48 offen offset:3072 sc1 nt
s_cmp_lg_u32 s44, 0
s_cbranch_scc1 L_pick
s_lshl_b32 s30, s25, 2
v_mov_b32 v1, s30
v_mov_b32 v2, s43
ds_write_b32 v1, v2
s_waitcnt lgkmcnt(0)
s_barrier
v_mov_b32 v1, 0
ds_read_b128 v[4:7], v1
s_waitcnt lgkmcnt(0)
v_or_b32 v4, v4, v5
v_or_b32 v6, v6, v7
v_or_b32 v4, v4, v6
s_nop 1
v_readfirstlane_b32 s43, v4
s_nop 3
L_pick:
s_and_b32 s43, s43, 3
s_cmp_eq_u32 s43, 0
s_cbranch_scc1 L_done
s_ff1_i32_b32 s39, s43
s_bitset0_b32 s43, s39
s_mov_b32 s44, 1
s_mov_b64 s[50:51], 0
s_waitcnt vmcnt(0) lgkmcnt(0)
s_barrier
s_branch L_cold
L_done:
L_end:
s_endpgm
.fill 4096, 4, 0xBF800000
.section .rodata,"a"
.p2align 6
.amdhsa_kernel standalone__gqa_softmax__near_ridge_kernel
  .amdhsa_next_free_vgpr 512
  .amdhsa_next_free_sgpr 96
  .amdhsa_accum_offset 256
  .amdhsa_group_segment_fixed_size 0
  .amdhsa_kernarg_size 48
  .amdhsa_user_sgpr_count 2
  .amdhsa_user_sgpr_kernarg_segment_ptr 1
  .amdhsa_system_sgpr_workgroup_id_x 1
  .amdhsa_float_denorm_mode_32 3
.end_amdhsa_kernel
```
